```python
import torch

def _softmax(x, axis=-1):
    return torch.softmax(x, dim=axis)
def _gelu(x):
    return torch.nn.functional.gelu(x, approximate="tanh")
def _silu(x):
    return torch.nn.functional.silu(x)
def _sigmoid(x):
    return torch.sigmoid(x)
def _layernorm(x, axis=-1, eps=1e-5):
    m = x.mean(dim=axis, keepdim=True)
    v = x.var(dim=axis, keepdim=True, unbiased=False)
    return (x - m) / torch.sqrt(v + eps)
def _scatter_add(tgt, idx, src, axis=0):
    return tgt.clone().index_add_(axis, idx, src)
def _segment_sum(src, seg, n):
    out = torch.zeros((n,) + src.shape[1:], dtype=src.dtype)
    return out.index_add_(0, seg, src)
def _pad(x, pw):
    flat = tuple(v for pair in reversed(pw) for v in pair)
    return torch.nn.functional.pad(x, flat)

kernel_name = 'recurrent_scan__mha_block_cached__geglu_ffn__decode'

def setup_inputs():

    _w = (lambda a: (lambda t: t.to(torch.bfloat16) if t.is_floating_point() else t)(torch.as_tensor(a)))
    def _A_setup():
        B, Sq, D = 4, 1, 512
        H, Sk, Dh = 32, 8192, 128
        return {
            "x": _w((lambda *s: torch.randn(*s, dtype=torch.bfloat16) * 0.05)(B, Sq, D)),
            "k_cache": _w((lambda *s: torch.randn(*s, dtype=torch.bfloat16) * 1.6)(B, H, Sk, Dh)),
            "v_cache": _w((lambda *s: torch.randn(*s, dtype=torch.bfloat16) * 0.2)(B, H, Sk, Dh)),
            "wq": _w((lambda *s: torch.randn(*s, dtype=torch.bfloat16) * 1.6)(D, H * Dh) * (D ** -0.5)),
            "wo": _w((lambda *s: torch.randn(*s, dtype=torch.bfloat16) * 0.2)(H * Dh, D) * ((H * Dh) ** -0.5)),
        }
    _A_in = _A_setup()

    def _B_setup():
        B, S, D, F = 4, 1, 512, 1376
        return {
            "x": _w((lambda *s: torch.randn(*s, dtype=torch.bfloat16) * 0.05)(B, S, D)),
            "w_gate": _w((lambda *s: torch.randn(*s, dtype=torch.bfloat16) * 0.1)(D, F)),
            "w_up": _w((lambda *s: torch.randn(*s, dtype=torch.bfloat16) * 0.1)(D, F)),
            "w_down": _w((lambda *s: torch.randn(*s, dtype=torch.bfloat16) * 0.1)(F, D)),
        }
    _B_in = _B_setup()

    return {
        "A_x": _A_in["x"],
        "A_k_cache": _A_in["k_cache"],
        "A_v_cache": _A_in["v_cache"],
        "A_wq": _A_in["wq"],
        "A_wo": _A_in["wo"],
        "B_x": _B_in["x"],
        "B_w_gate": _B_in["w_gate"],
        "B_w_up": _B_in["w_up"],
        "B_w_down": _B_in["w_down"],
    }

def reference(A_x, A_k_cache, A_v_cache, A_wq, A_wo, B_x, B_w_gate, B_w_up, B_w_down):
    def _A_ref(x, k_cache, v_cache, wq, wo):
        B, Sq, D = x.shape
        H, Dh = 32, 128
        q = (lambda x, *d: x.permute(*d))((x @ wq).reshape(B, Sq, H, Dh), 0, 2, 1, 3)
        scores = torch.einsum("bhqd,bhkd->bhqk", q, k_cache) * (Dh ** -0.5)
        p = _softmax(scores, axis=-1)
        o = torch.einsum("bhqk,bhkd->bhqd", p, v_cache)
        return (lambda x, *d: x.permute(*d))(o, 0, 2, 1, 3).reshape(B, Sq, H * Dh) @ wo

    def _B_ref(x, w_gate, w_up, w_down):
        return (_gelu(x @ w_gate) * (x @ w_up)) @ w_down

    x = A_x
    xn = _layernorm(x, axis=-1)
    s = _A_ref(xn, A_k_cache, A_v_cache, A_wq, A_wo)
    g = _silu(_B_ref(xn, B_w_gate, B_w_up, B_w_down))
    return x + s * g
```

```asm
; @launch kernel=attn_ffn_kernel grid=(256,1,1) block=(512,1,1) lds=80896
; @launch kernel=final_kernel grid=(64,1,1) block=(256,1,1) lds=1024
.amdgcn_target "amdgcn-amd-amdhsa--gfx950"
.text
.p2align 8
.globl attn_ffn_kernel
.type attn_ffn_kernel,@function
attn_ffn_kernel:
  s_cmp_ge_u32 s2, 256
  s_cbranch_scc1 A_end
  s_load_dwordx8 s[4:11], s[0:1], 0
  s_load_dwordx2 s[12:13], s[0:1], 32
  s_load_dwordx4 s[16:19], s[0:1], 48
  s_load_dwordx2 s[20:21], s[0:1], 64
  s_load_dwordx4 s[24:27], s[0:1], 80
  v_lshrrev_b32 v2, 6, v0
  v_and_b32 v1, 63, v0
  v_readfirstlane_b32 s3, v2
  v_mov_b32 v60, 0
  v_mov_b32 v61, 1
  v_lshlrev_b32 v2, 2, v1
  ds_write_b32 v2, v60 offset:0
  s_and_b32 s45, s2, 7
  s_lshr_b32 s42, s2, 7
  s_lshr_b32 s44, s2, 3
  s_and_b32 s39, s44, 3
  s_lshl_b32 s40, s39, 3
  s_add_u32 s40, s40, s45
  s_lshr_b32 s41, s44, 2
  s_and_b32 s41, s41, 3
  s_lshl_b32 s39, s39, 1
  s_lshl_b32 s43, s41, 5
  s_add_u32 s43, s43, s40
  s_lshl_b32 s46, s43, 1
  s_add_u32 s46, s46, s42
  s_lshl_b32 s58, s41, 1
  s_add_u32 s58, s58, s42
  v_lshrrev_b32 v3, 4, v1
  v_and_b32 v4, 15, v1
  v_lshlrev_b32 v5, 4, v1
  s_waitcnt lgkmcnt(0)
  s_barrier
  s_cmp_lt_u32 s3, 4
  s_cbranch_scc1 A_helper
  s_sub_u32 s3, s3, 4
  s_lshl_b32 s47, s43, 21
  s_add_u32 s28, s6, s47
  s_addc_u32 s29, s7, 0
  s_mov_b32 s30, 0x200000
  s_mov_b32 s31, 0x20000
  s_add_u32 s32, s8, s47
  s_addc_u32 s33, s9, 0
  s_mov_b32 s34, 0x200000
  s_mov_b32 s35, 0x20000
  s_lshl_b32 s70, s42, 7
  s_xor_b32 s71, s3, 1
  s_add_u32 s71, s71, s70
  s_add_u32 s70, s70, s3
  s_lshl_b32 s70, s70, 13
  s_lshl_b32 s71, s71, 13
  s_add_u32 s36, s70, 0
  s_add_u32 s37, s36, 4096
  buffer_load_dwordx4 v[64:67], v5, s[28:31], s36 offen offset:0 nt
  buffer_load_dwordx4 v[68:71], v5, s[28:31], s36 offen offset:1024 nt
  buffer_load_dwordx4 v[72:75], v5, s[28:31], s36 offen offset:2048 nt
  buffer_load_dwordx4 v[76:79], v5, s[28:31], s36 offen offset:3072 nt
  buffer_load_dwordx4 v[80:83], v5, s[28:31], s37 offen offset:0 nt
  s_waitcnt vmcnt(4)
  buffer_load_dwordx4 v[84:87], v5, s[28:31], s37 offen offset:1024 nt
  s_waitcnt vmcnt(4)
  buffer_load_dwordx4 v[88:91], v5, s[28:31], s37 offen offset:2048 nt
  s_waitcnt vmcnt(4)
  buffer_load_dwordx4 v[92:95], v5, s[28:31], s37 offen offset:3072 nt
  s_add_u32 s36, s71, 32768
  s_add_u32 s37, s36, 4096
  s_waitcnt vmcnt(4)
  buffer_load_dwordx4 v[96:99], v5, s[28:31], s36 offen offset:0 nt
  s_waitcnt vmcnt(4)
  buffer_load_dwordx4 v[100:103], v5, s[28:31], s36 offen offset:1024 nt
  s_waitcnt vmcnt(4)
  buffer_load_dwordx4 v[104:107], v5, s[28:31], s36 offen offset:2048 nt
  s_waitcnt vmcnt(4)
  buffer_load_dwordx4 v[108:111], v5, s[28:31], s36 offen offset:3072 nt
  s_waitcnt vmcnt(4)
  buffer_load_dwordx4 v[112:115], v5, s[28:31], s37 offen offset:0 nt
  s_waitcnt vmcnt(4)
  buffer_load_dwordx4 v[116:119], v5, s[28:31], s37 offen offset:1024 nt
  s_waitcnt vmcnt(4)
  buffer_load_dwordx4 v[120:123], v5, s[28:31], s37 offen offset:2048 nt
  s_waitcnt vmcnt(4)
  buffer_load_dwordx4 v[124:127], v5, s[28:31], s37 offen offset:3072 nt
  s_add_u32 s36, s70, 65536
  s_add_u32 s37, s36, 4096
  s_waitcnt vmcnt(4)
  buffer_load_dwordx4 v[128:131], v5, s[28:31], s36 offen offset:0 nt
  s_waitcnt vmcnt(4)
  buffer_load_dwordx4 v[132:135], v5, s[28:31], s36 offen offset:1024 nt
  s_waitcnt vmcnt(4)
  buffer_load_dwordx4 v[136:139], v5, s[28:31], s36 offen offset:2048 nt
  s_waitcnt vmcnt(4)
  buffer_load_dwordx4 v[140:143], v5, s[28:31], s36 offen offset:3072 nt
  s_waitcnt vmcnt(4)
  buffer_load_dwordx4 v[144:147], v5, s[28:31], s37 offen offset:0 nt
  s_waitcnt vmcnt(4)
  buffer_load_dwordx4 v[148:151], v5, s[28:31], s37 offen offset:1024 nt
  s_waitcnt vmcnt(4)
  buffer_load_dwordx4 v[152:155], v5, s[28:31], s37 offen offset:2048 nt
  s_waitcnt vmcnt(4)
  buffer_load_dwordx4 v[156:159], v5, s[28:31], s37 offen offset:3072 nt
  s_add_u32 s36, s71, 98304
  s_add_u32 s37, s36, 4096
  s_waitcnt vmcnt(4)
  buffer_load_dwordx4 v[160:163], v5, s[28:31], s36 offen offset:0 nt
  s_waitcnt vmcnt(4)
  buffer_load_dwordx4 v[164:167], v5, s[28:31], s36 offen offset:1024 nt
  s_waitcnt vmcnt(4)
  buffer_load_dwordx4 v[168:171], v5, s[28:31], s36 offen offset:2048 nt
  s_waitcnt vmcnt(4)
  buffer_load_dwordx4 v[172:175], v5, s[28:31], s36 offen offset:3072 nt
  s_waitcnt vmcnt(4)
  buffer_load_dwordx4 v[176:179], v5, s[28:31], s37 offen offset:0 nt
  s_waitcnt vmcnt(4)
  buffer_load_dwordx4 v[180:183], v5, s[28:31], s37 offen offset:1024 nt
  s_waitcnt vmcnt(4)
  buffer_load_dwordx4 v[184:187], v5, s[28:31], s37 offen offset:2048 nt
  s_waitcnt vmcnt(4)
  buffer_load_dwordx4 v[188:191], v5, s[28:31], s37 offen offset:3072 nt
  s_add_u32 s36, s70, 131072
  s_add_u32 s37, s36, 4096
  s_waitcnt vmcnt(4)
  buffer_load_dwordx4 v[192:195], v5, s[28:31], s36 offen offset:0 nt
  s_waitcnt vmcnt(4)
  buffer_load_dwordx4 v[196:199], v5, s[28:31], s36 offen offset:1024 nt
  s_waitcnt vmcnt(4)
  buffer_load_dwordx4 v[200:203], v5, s[28:31], s36 offen offset:2048 nt
  s_waitcnt vmcnt(4)
  buffer_load_dwordx4 v[204:207], v5, s[28:31], s36 offen offset:3072 nt
  s_waitcnt vmcnt(4)
  buffer_load_dwordx4 v[208:211], v5, s[28:31], s37 offen offset:0 nt
  s_waitcnt vmcnt(4)
  buffer_load_dwordx4 v[212:215], v5, s[28:31], s37 offen offset:1024 nt
  s_waitcnt vmcnt(4)
  buffer_load_dwordx4 v[216:219], v5, s[28:31], s37 offen offset:2048 nt
  s_waitcnt vmcnt(4)
  buffer_load_dwordx4 v[220:223], v5, s[28:31], s37 offen offset:3072 nt
  s_add_u32 s36, s71, 163840
  s_add_u32 s37, s36, 4096
  s_waitcnt vmcnt(4)
  buffer_load_dwordx4 v[224:227], v5, s[28:31], s36 offen offset:0 nt
  s_waitcnt vmcnt(4)
  buffer_load_dwordx4 v[228:231], v5, s[28:31], s36 offen offset:1024 nt
  s_waitcnt vmcnt(4)
  buffer_load_dwordx4 v[232:235], v5, s[28:31], s36 offen offset:2048 nt
  s_waitcnt vmcnt(4)
  buffer_load_dwordx4 v[236:239], v5, s[28:31], s36 offen offset:3072 nt
  s_waitcnt vmcnt(4)
  buffer_load_dwordx4 v[240:243], v5, s[28:31], s37 offen offset:0 nt
  s_waitcnt vmcnt(4)
  buffer_load_dwordx4 v[244:247], v5, s[28:31], s37 offen offset:1024 nt
  s_waitcnt vmcnt(4)
  buffer_load_dwordx4 v[248:251], v5, s[28:31], s37 offen offset:2048 nt
  s_waitcnt vmcnt(4)
  buffer_load_dwordx4 v[252:255], v5, s[28:31], s37 offen offset:3072 nt
  v_mov_b32 v20, 0
  v_mov_b32 v21, 0
  v_mov_b32 v22, 0
  v_mov_b32 v23, 0
  v_mov_b32 v24, 0
  v_mov_b32 v25, 0
  v_mov_b32 v26, 0
  v_mov_b32 v27, 0
  v_mov_b32 v28, 0xff7fffff
  v_mov_b32 v29, 0
  s_mov_b32 s50, 0xcccccccc
  s_mov_b32 s51, 0xcccccccc
  s_mov_b32 s52, 0x3db504f3
  s_mov_b32 s53, 0x3fb8aa3b
  v_lshlrev_b32 v6, 5, v4
  v_lshlrev_b32 v7, 4, v4
  s_lshl_b32 s48, s3, 12
  s_add_u32 s48, s48, 64512
  v_lshrrev_b32 v41, 1, v1
  v_lshl_add_u32 v41, v41, 2, s48
  v_mov_b32 v42, v41
  v_mov_b32 v40, 3
  s_barrier
  ds_read_b128 v[8:11], v7 offset:256
  s_waitcnt lgkmcnt(0)
  s_waitcnt vmcnt(47)
  v_dot2_f32_bf16 v12, v64, v8, 0
  v_dot2_f32_bf16 v12, v65, v9, v12
  v_dot2_f32_bf16 v12, v66, v10, v12
  v_dot2_f32_bf16 v12, v67, v11, v12
  s_waitcnt vmcnt(46)
  v_dot2_f32_bf16 v13, v68, v8, 0
  v_dot2_f32_bf16 v13, v69, v9, v13
  v_dot2_f32_bf16 v13, v70, v10, v13
  v_dot2_f32_bf16 v13, v71, v11, v13
  s_waitcnt vmcnt(45)
  v_dot2_f32_bf16 v14, v72, v8, 0
  v_dot2_f32_bf16 v14, v73, v9, v14
  v_dot2_f32_bf16 v14, v74, v10, v14
  v_dot2_f32_bf16 v14, v75, v11, v14
  s_waitcnt vmcnt(44)
  v_dot2_f32_bf16 v15, v76, v8, 0
  v_dot2_f32_bf16 v15, v77, v9, v15
  v_dot2_f32_bf16 v15, v78, v10, v15
  v_dot2_f32_bf16 v15, v79, v11, v15
  s_waitcnt vmcnt(43)
  v_dot2_f32_bf16 v16, v80, v8, 0
  v_dot2_f32_bf16 v16, v81, v9, v16
  v_dot2_f32_bf16 v16, v82, v10, v16
  v_dot2_f32_bf16 v16, v83, v11, v16
  s_waitcnt vmcnt(42)
  v_dot2_f32_bf16 v17, v84, v8, 0
  v_dot2_f32_bf16 v17, v85, v9, v17
  v_dot2_f32_bf16 v17, v86, v10, v17
  v_dot2_f32_bf16 v17, v87, v11, v17
  s_waitcnt vmcnt(41)
  v_dot2_f32_bf16 v18, v88, v8, 0
  v_dot2_f32_bf16 v18, v89, v9, v18
  v_dot2_f32_bf16 v18, v90, v10, v18
  v_dot2_f32_bf16 v18, v91, v11, v18
  s_waitcnt vmcnt(40)
  v_dot2_f32_bf16 v19, v92, v8, 0
  v_dot2_f32_bf16 v19, v93, v9, v19
  v_dot2_f32_bf16 v19, v94, v10, v19
  v_dot2_f32_bf16 v19, v95, v11, v19
  v_add_f32_dpp v12, v12, v12 row_ror:8 row_mask:0xf bank_mask:0x3
  v_add_f32_dpp v14, v14, v14 row_ror:8 row_mask:0xf bank_mask:0x3
  v_add_f32_dpp v16, v16, v16 row_ror:8 row_mask:0xf bank_mask:0x3
  v_add_f32_dpp v18, v18, v18 row_ror:8 row_mask:0xf bank_mask:0x3
  v_add_f32_dpp v12, v13, v13 row_ror:8 row_mask:0xf bank_mask:0xc
  v_add_f32_dpp v14, v15, v15 row_ror:8 row_mask:0xf bank_mask:0xc
  v_add_f32_dpp v16, v17, v17 row_ror:8 row_mask:0xf bank_mask:0xc
  v_add_f32_dpp v18, v19, v19 row_ror:8 row_mask:0xf bank_mask:0xc
  v_add_f32_dpp v12, v12, v12 row_half_mirror row_mask:0xf bank_mask:0x5
  v_add_f32_dpp v16, v16, v16 row_half_mirror row_mask:0xf bank_mask:0x5
  s_nop 0
  v_add_f32_dpp v12, v14, v14 row_half_mirror row_mask:0xf bank_mask:0xa
  v_add_f32_dpp v16, v18, v18 row_half_mirror row_mask:0xf bank_mask:0xa
  s_nop 0
  v_add_f32_dpp v31, v12, v12 quad_perm:[2,3,0,1] row_mask:0xf bank_mask:0xf
  v_add_f32_dpp v32, v16, v16 quad_perm:[2,3,0,1] row_mask:0xf bank_mask:0xf
  v_cndmask_b32 v30, v31, v32, s[50:51]
  s_nop 1
  v_add_f32_dpp v30, v30, v30 quad_perm:[1,0,3,2] row_mask:0xf bank_mask:0xf
  v_cvt_pk_bf16_f32 v31, v30, v30
  v_and_b32 v30, 0xffff0000, v31
  v_mul_f32 v30, s52, v30
  v_cvt_pk_bf16_f32 v31, v30, v30
  v_and_b32 v30, 0xffff0000, v31
  ds_write_b32 v42, v30
  v_add_u32 v42, 128, v42
  s_mov_b32 s38, 196608
  s_nop 3
A_kloop:
  ds_write_b32 v60, v40 offset:32
  v_add_u32 v40, 3, v40
  s_add_u32 s36, s70, s38
  s_add_u32 s37, s36, 4096
  s_add_u32 s38, s38, 32768
  s_waitcnt vmcnt(32)
  s_waitcnt vmcnt(4)
  buffer_load_dwordx4 v[64:67], v5, s[28:31], s36 offen offset:0 nt
  v_dot2_f32_bf16 v12, v96, v8, 0
  v_dot2_f32_bf16 v12, v97, v9, v12
  v_dot2_f32_bf16 v12, v98, v10, v12
  v_dot2_f32_bf16 v12, v99, v11, v12
  v_dot2_f32_bf16 v13, v100, v8, 0
  v_dot2_f32_bf16 v13, v101, v9, v13
  v_dot2_f32_bf16 v13, v102, v10, v13
  v_dot2_f32_bf16 v13, v103, v11, v13
  s_waitcnt vmcnt(4)
  buffer_load_dwordx4 v[68:71], v5, s[28:31], s36 offen offset:1024 nt
  v_dot2_f32_bf16 v14, v104, v8, 0
  v_dot2_f32_bf16 v14, v105, v9, v14
  v_dot2_f32_bf16 v14, v106, v10, v14
  v_dot2_f32_bf16 v14, v107, v11, v14
  v_dot2_f32_bf16 v15, v108, v8, 0
  v_dot2_f32_bf16 v15, v109, v9, v15
  v_dot2_f32_bf16 v15, v110, v10, v15
  v_dot2_f32_bf16 v15, v111, v11, v15
  s_waitcnt vmcnt(4)
  buffer_load_dwordx4 v[72:75], v5, s[28:31], s36 offen offset:2048 nt
  v_dot2_f32_bf16 v16, v112, v8, 0
  v_dot2_f32_bf16 v16, v113, v9, v16
  v_dot2_f32_bf16 v16, v114, v10, v16
  v_dot2_f32_bf16 v16, v115, v11, v16
  v_dot2_f32_bf16 v17, v116, v8, 0
  v_dot2_f32_bf16 v17, v117, v9, v17
  v_dot2_f32_bf16 v17, v118, v10, v17
  v_dot2_f32_bf16 v17, v119, v11, v17
  s_waitcnt vmcnt(4)
  buffer_load_dwordx4 v[76:79], v5, s[28:31], s36 offen offset:3072 nt
  v_dot2_f32_bf16 v18, v120, v8, 0
  v_dot2_f32_bf16 v18, v121, v9, v18
  v_dot2_f32_bf16 v18, v122, v10, v18
  v_dot2_f32_bf16 v18, v123, v11, v18
  v_dot2_f32_bf16 v19, v124, v8, 0
  v_dot2_f32_bf16 v19, v125, v9, v19
  v_dot2_f32_bf16 v19, v126, v10, v19
  v_dot2_f32_bf16 v19, v127, v11, v19
  s_waitcnt vmcnt(4)
  buffer_load_dwordx4 v[80:83], v5, s[28:31], s37 offen offset:0 nt
  v_add_f32_dpp v12, v12, v12 row_ror:8 row_mask:0xf bank_mask:0x3
  v_add_f32_dpp v14, v14, v14 row_ror:8 row_mask:0xf bank_mask:0x3
  v_add_f32_dpp v16, v16, v16 row_ror:8 row_mask:0xf bank_mask:0x3
  v_add_f32_dpp v18, v18, v18 row_ror:8 row_mask:0xf bank_mask:0x3
  v_add_f32_dpp v12, v13, v13 row_ror:8 row_mask:0xf bank_mask:0xc
  v_add_f32_dpp v14, v15, v15 row_ror:8 row_mask:0xf bank_mask:0xc
  v_add_f32_dpp v16, v17, v17 row_ror:8 row_mask:0xf bank_mask:0xc
  v_add_f32_dpp v18, v19, v19 row_ror:8 row_mask:0xf bank_mask:0xc
  s_waitcnt vmcnt(4)
  buffer_load_dwordx4 v[84:87], v5, s[28:31], s37 offen offset:1024 nt
  v_add_f32_dpp v12, v12, v12 row_half_mirror row_mask:0xf bank_mask:0x5
  v_add_f32_dpp v16, v16, v16 row_half_mirror row_mask:0xf bank_mask:0x5
  s_nop 0
  v_add_f32_dpp v12, v14, v14 row_half_mirror row_mask:0xf bank_mask:0xa
  v_add_f32_dpp v16, v18, v18 row_half_mirror row_mask:0xf bank_mask:0xa
  s_nop 0
  v_add_f32_dpp v31, v12, v12 quad_perm:[2,3,0,1] row_mask:0xf bank_mask:0xf
  v_add_f32_dpp v32, v16, v16 quad_perm:[2,3,0,1] row_mask:0xf bank_mask:0xf
  v_cndmask_b32 v30, v31, v32, s[50:51]
  s_nop 1
  v_add_f32_dpp v30, v30, v30 quad_perm:[1,0,3,2] row_mask:0xf bank_mask:0xf
  s_waitcnt vmcnt(4)
  buffer_load_dwordx4 v[88:91], v5, s[28:31], s37 offen offset:2048 nt
  v_cvt_pk_bf16_f32 v31, v30, v30
  v_and_b32 v30, 0xffff0000, v31
  v_mul_f32 v30, s52, v30
  v_cvt_pk_bf16_f32 v31, v30, v30
  v_and_b32 v30, 0xffff0000, v31
  s_waitcnt vmcnt(4)
  buffer_load_dwordx4 v[92:95], v5, s[28:31], s37 offen offset:3072 nt
  ds_write_b32 v42, v30
  v_add_u32 v42, 128, v42
  s_add_u32 s36, s71, s38
  s_add_u32 s37, s36, 4096
  s_add_u32 s38, s38, 32768
  s_waitcnt vmcnt(32)
  s_waitcnt vmcnt(4)
  buffer_load_dwordx4 v[96:99], v5, s[28:31], s36 offen offset:0 nt
  v_dot2_f32_bf16 v12, v128, v8, 0
  v_dot2_f32_bf16 v12, v129, v9, v12
  v_dot2_f32_bf16 v12, v130, v10, v12
  v_dot2_f32_bf16 v12, v131, v11, v12
  v_dot2_f32_bf16 v13, v132, v8, 0
  v_dot2_f32_bf16 v13, v133, v9, v13
  v_dot2_f32_bf16 v13, v134, v10, v13
  v_dot2_f32_bf16 v13, v135, v11, v13
  s_waitcnt vmcnt(4)
  buffer_load_dwordx4 v[100:103], v5, s[28:31], s36 offen offset:1024 nt
  v_dot2_f32_bf16 v14, v136, v8, 0
  v_dot2_f32_bf16 v14, v137, v9, v14
  v_dot2_f32_bf16 v14, v138, v10, v14
  v_dot2_f32_bf16 v14, v139, v11, v14
  v_dot2_f32_bf16 v15, v140, v8, 0
  v_dot2_f32_bf16 v15, v141, v9, v15
  v_dot2_f32_bf16 v15, v142, v10, v15
  v_dot2_f32_bf16 v15, v143, v11, v15
  s_waitcnt vmcnt(4)
  buffer_load_dwordx4 v[104:107], v5, s[28:31], s36 offen offset:2048 nt
  v_dot2_f32_bf16 v16, v144, v8, 0
  v_dot2_f32_bf16 v16, v145, v9, v16
  v_dot2_f32_bf16 v16, v146, v10, v16
  v_dot2_f32_bf16 v16, v147, v11, v16
  v_dot2_f32_bf16 v17, v148, v8, 0
  v_dot2_f32_bf16 v17, v149, v9, v17
  v_dot2_f32_bf16 v17, v150, v10, v17
  v_dot2_f32_bf16 v17, v151, v11, v17
  s_waitcnt vmcnt(4)
  buffer_load_dwordx4 v[108:111], v5, s[28:31], s36 offen offset:3072 nt
  v_dot2_f32_bf16 v18, v152, v8, 0
  v_dot2_f32_bf16 v18, v153, v9, v18
  v_dot2_f32_bf16 v18, v154, v10, v18
  v_dot2_f32_bf16 v18, v155, v11, v18
  v_dot2_f32_bf16 v19, v156, v8, 0
  v_dot2_f32_bf16 v19, v157, v9, v19
  v_dot2_f32_bf16 v19, v158, v10, v19
  v_dot2_f32_bf16 v19, v159, v11, v19
  s_waitcnt vmcnt(4)
  buffer_load_dwordx4 v[112:115], v5, s[28:31], s37 offen offset:0 nt
  v_add_f32_dpp v12, v12, v12 row_ror:8 row_mask:0xf bank_mask:0x3
  v_add_f32_dpp v14, v14, v14 row_ror:8 row_mask:0xf bank_mask:0x3
  v_add_f32_dpp v16, v16, v16 row_ror:8 row_mask:0xf bank_mask:0x3
  v_add_f32_dpp v18, v18, v18 row_ror:8 row_mask:0xf bank_mask:0x3
  v_add_f32_dpp v12, v13, v13 row_ror:8 row_mask:0xf bank_mask:0xc
  v_add_f32_dpp v14, v15, v15 row_ror:8 row_mask:0xf bank_mask:0xc
  v_add_f32_dpp v16, v17, v17 row_ror:8 row_mask:0xf bank_mask:0xc
  v_add_f32_dpp v18, v19, v19 row_ror:8 row_mask:0xf bank_mask:0xc
  s_waitcnt vmcnt(4)
  buffer_load_dwordx4 v[116:119], v5, s[28:31], s37 offen offset:1024 nt
  v_add_f32_dpp v12, v12, v12 row_half_mirror row_mask:0xf bank_mask:0x5
  v_add_f32_dpp v16, v16, v16 row_half_mirror row_mask:0xf bank_mask:0x5
  s_nop 0
  v_add_f32_dpp v12, v14, v14 row_half_mirror row_mask:0xf bank_mask:0xa
  v_add_f32_dpp v16, v18, v18 row_half_mirror row_mask:0xf bank_mask:0xa
  s_nop 0
  v_add_f32_dpp v31, v12, v12 quad_perm:[2,3,0,1] row_mask:0xf bank_mask:0xf
  v_add_f32_dpp v32, v16, v16 quad_perm:[2,3,0,1] row_mask:0xf bank_mask:0xf
  v_cndmask_b32 v30, v31, v32, s[50:51]
  s_nop 1
  v_add_f32_dpp v30, v30, v30 quad_perm:[1,0,3,2] row_mask:0xf bank_mask:0xf
  s_waitcnt vmcnt(4)
  buffer_load_dwordx4 v[120:123], v5, s[28:31], s37 offen offset:2048 nt
  v_cvt_pk_bf16_f32 v31, v30, v30
  v_and_b32 v30, 0xffff0000, v31
  v_mul_f32 v30, s52, v30
  v_cvt_pk_bf16_f32 v31, v30, v30
  v_and_b32 v30, 0xffff0000, v31
  s_waitcnt vmcnt(4)
  buffer_load_dwordx4 v[124:127], v5, s[28:31], s37 offen offset:3072 nt
  ds_write_b32 v42, v30
  v_add_u32 v42, 128, v42
  s_add_u32 s36, s70, s38
  s_add_u32 s37, s36, 4096
  s_add_u32 s38, s38, 32768
  s_waitcnt vmcnt(32)
  s_waitcnt vmcnt(4)
  buffer_load_dwordx4 v[128:131], v5, s[28:31], s36 offen offset:0 nt
  v_dot2_f32_bf16 v12, v160, v8, 0
  v_dot2_f32_bf16 v12, v161, v9, v12
  v_dot2_f32_bf16 v12, v162, v10, v12
  v_dot2_f32_bf16 v12, v163, v11, v12
  v_dot2_f32_bf16 v13, v164, v8, 0
  v_dot2_f32_bf16 v13, v165, v9, v13
  v_dot2_f32_bf16 v13, v166, v10, v13
  v_dot2_f32_bf16 v13, v167, v11, v13
  s_waitcnt vmcnt(4)
  buffer_load_dwordx4 v[132:135], v5, s[28:31], s36 offen offset:1024 nt
  v_dot2_f32_bf16 v14, v168, v8, 0
  v_dot2_f32_bf16 v14, v169, v9, v14
  v_dot2_f32_bf16 v14, v170, v10, v14
  v_dot2_f32_bf16 v14, v171, v11, v14
  v_dot2_f32_bf16 v15, v172, v8, 0
  v_dot2_f32_bf16 v15, v173, v9, v15
  v_dot2_f32_bf16 v15, v174, v10, v15
  v_dot2_f32_bf16 v15, v175, v11, v15
  s_waitcnt vmcnt(4)
  buffer_load_dwordx4 v[136:139], v5, s[28:31], s36 offen offset:2048 nt
  v_dot2_f32_bf16 v16, v176, v8, 0
  v_dot2_f32_bf16 v16, v177, v9, v16
  v_dot2_f32_bf16 v16, v178, v10, v16
  v_dot2_f32_bf16 v16, v179, v11, v16
  v_dot2_f32_bf16 v17, v180, v8, 0
  v_dot2_f32_bf16 v17, v181, v9, v17
  v_dot2_f32_bf16 v17, v182, v10, v17
  v_dot2_f32_bf16 v17, v183, v11, v17
  s_waitcnt vmcnt(4)
  buffer_load_dwordx4 v[140:143], v5, s[28:31], s36 offen offset:3072 nt
  v_dot2_f32_bf16 v18, v184, v8, 0
  v_dot2_f32_bf16 v18, v185, v9, v18
  v_dot2_f32_bf16 v18, v186, v10, v18
  v_dot2_f32_bf16 v18, v187, v11, v18
  v_dot2_f32_bf16 v19, v188, v8, 0
  v_dot2_f32_bf16 v19, v189, v9, v19
  v_dot2_f32_bf16 v19, v190, v10, v19
  v_dot2_f32_bf16 v19, v191, v11, v19
  s_waitcnt vmcnt(4)
  buffer_load_dwordx4 v[144:147], v5, s[28:31], s37 offen offset:0 nt
  v_add_f32_dpp v12, v12, v12 row_ror:8 row_mask:0xf bank_mask:0x3
  v_add_f32_dpp v14, v14, v14 row_ror:8 row_mask:0xf bank_mask:0x3
  v_add_f32_dpp v16, v16, v16 row_ror:8 row_mask:0xf bank_mask:0x3
  v_add_f32_dpp v18, v18, v18 row_ror:8 row_mask:0xf bank_mask:0x3
  v_add_f32_dpp v12, v13, v13 row_ror:8 row_mask:0xf bank_mask:0xc
  v_add_f32_dpp v14, v15, v15 row_ror:8 row_mask:0xf bank_mask:0xc
  v_add_f32_dpp v16, v17, v17 row_ror:8 row_mask:0xf bank_mask:0xc
  v_add_f32_dpp v18, v19, v19 row_ror:8 row_mask:0xf bank_mask:0xc
  s_waitcnt vmcnt(4)
  buffer_load_dwordx4 v[148:151], v5, s[28:31], s37 offen offset:1024 nt
  v_add_f32_dpp v12, v12, v12 row_half_mirror row_mask:0xf bank_mask:0x5
  v_add_f32_dpp v16, v16, v16 row_half_mirror row_mask:0xf bank_mask:0x5
  s_nop 0
  v_add_f32_dpp v12, v14, v14 row_half_mirror row_mask:0xf bank_mask:0xa
  v_add_f32_dpp v16, v18, v18 row_half_mirror row_mask:0xf bank_mask:0xa
  s_nop 0
  v_add_f32_dpp v31, v12, v12 quad_perm:[2,3,0,1] row_mask:0xf bank_mask:0xf
  v_add_f32_dpp v32, v16, v16 quad_perm:[2,3,0,1] row_mask:0xf bank_mask:0xf
  v_cndmask_b32 v30, v31, v32, s[50:51]
  s_nop 1
  v_add_f32_dpp v30, v30, v30 quad_perm:[1,0,3,2] row_mask:0xf bank_mask:0xf
  s_waitcnt vmcnt(4)
  buffer_load_dwordx4 v[152:155], v5, s[28:31], s37 offen offset:2048 nt
  v_cvt_pk_bf16_f32 v31, v30, v30
  v_and_b32 v30, 0xffff0000, v31
  v_mul_f32 v30, s52, v30
  v_cvt_pk_bf16_f32 v31, v30, v30
  v_and_b32 v30, 0xffff0000, v31
  s_waitcnt vmcnt(4)
  buffer_load_dwordx4 v[156:159], v5, s[28:31], s37 offen offset:3072 nt
  ds_write_b32 v42, v30
  v_add_u32 v42, 128, v42
  s_add_u32 s36, s71, s38
  s_add_u32 s37, s36, 4096
  s_add_u32 s38, s38, 32768
  s_waitcnt vmcnt(32)
  s_waitcnt vmcnt(4)
  buffer_load_dwordx4 v[160:163], v5, s[28:31], s36 offen offset:0 nt
  v_dot2_f32_bf16 v12, v192, v8, 0
  v_dot2_f32_bf16 v12, v193, v9, v12
  v_dot2_f32_bf16 v12, v194, v10, v12
  v_dot2_f32_bf16 v12, v195, v11, v12
  v_dot2_f32_bf16 v13, v196, v8, 0
  v_dot2_f32_bf16 v13, v197, v9, v13
  v_dot2_f32_bf16 v13, v198, v10, v13
  v_dot2_f32_bf16 v13, v199, v11, v13
  s_waitcnt vmcnt(4)
  buffer_load_dwordx4 v[164:167], v5, s[28:31], s36 offen offset:1024 nt
  v_dot2_f32_bf16 v14, v200, v8, 0
  v_dot2_f32_bf16 v14, v201, v9, v14
  v_dot2_f32_bf16 v14, v202, v10, v14
  v_dot2_f32_bf16 v14, v203, v11, v14
  v_dot2_f32_bf16 v15, v204, v8, 0
  v_dot2_f32_bf16 v15, v205, v9, v15
  v_dot2_f32_bf16 v15, v206, v10, v15
  v_dot2_f32_bf16 v15, v207, v11, v15
  s_waitcnt vmcnt(4)
  buffer_load_dwordx4 v[168:171], v5, s[28:31], s36 offen offset:2048 nt
  v_dot2_f32_bf16 v16, v208, v8, 0
  v_dot2_f32_bf16 v16, v209, v9, v16
  v_dot2_f32_bf16 v16, v210, v10, v16
  v_dot2_f32_bf16 v16, v211, v11, v16
  v_dot2_f32_bf16 v17, v212, v8, 0
  v_dot2_f32_bf16 v17, v213, v9, v17
  v_dot2_f32_bf16 v17, v214, v10, v17
  v_dot2_f32_bf16 v17, v215, v11, v17
  s_waitcnt vmcnt(4)
  buffer_load_dwordx4 v[172:175], v5, s[28:31], s36 offen offset:3072 nt
  v_dot2_f32_bf16 v18, v216, v8, 0
  v_dot2_f32_bf16 v18, v217, v9, v18
  v_dot2_f32_bf16 v18, v218, v10, v18
  v_dot2_f32_bf16 v18, v219, v11, v18
  v_dot2_f32_bf16 v19, v220, v8, 0
  v_dot2_f32_bf16 v19, v221, v9, v19
  v_dot2_f32_bf16 v19, v222, v10, v19
  v_dot2_f32_bf16 v19, v223, v11, v19
  s_waitcnt vmcnt(4)
  buffer_load_dwordx4 v[176:179], v5, s[28:31], s37 offen offset:0 nt
  v_add_f32_dpp v12, v12, v12 row_ror:8 row_mask:0xf bank_mask:0x3
  v_add_f32_dpp v14, v14, v14 row_ror:8 row_mask:0xf bank_mask:0x3
  v_add_f32_dpp v16, v16, v16 row_ror:8 row_mask:0xf bank_mask:0x3
  v_add_f32_dpp v18, v18, v18 row_ror:8 row_mask:0xf bank_mask:0x3
  v_add_f32_dpp v12, v13, v13 row_ror:8 row_mask:0xf bank_mask:0xc
  v_add_f32_dpp v14, v15, v15 row_ror:8 row_mask:0xf bank_mask:0xc
  v_add_f32_dpp v16, v17, v17 row_ror:8 row_mask:0xf bank_mask:0xc
  v_add_f32_dpp v18, v19, v19 row_ror:8 row_mask:0xf bank_mask:0xc
  s_waitcnt vmcnt(4)
  buffer_load_dwordx4 v[180:183], v5, s[28:31], s37 offen offset:1024 nt
  v_add_f32_dpp v12, v12, v12 row_half_mirror row_mask:0xf bank_mask:0x5
  v_add_f32_dpp v16, v16, v16 row_half_mirror row_mask:0xf bank_mask:0x5
  s_nop 0
  v_add_f32_dpp v12, v14, v14 row_half_mirror row_mask:0xf bank_mask:0xa
  v_add_f32_dpp v16, v18, v18 row_half_mirror row_mask:0xf bank_mask:0xa
  s_nop 0
  v_add_f32_dpp v31, v12, v12 quad_perm:[2,3,0,1] row_mask:0xf bank_mask:0xf
  v_add_f32_dpp v32, v16, v16 quad_perm:[2,3,0,1] row_mask:0xf bank_mask:0xf
  v_cndmask_b32 v30, v31, v32, s[50:51]
  s_nop 1
  v_add_f32_dpp v30, v30, v30 quad_perm:[1,0,3,2] row_mask:0xf bank_mask:0xf
  s_waitcnt vmcnt(4)
  buffer_load_dwordx4 v[184:187], v5, s[28:31], s37 offen offset:2048 nt
  v_cvt_pk_bf16_f32 v31, v30, v30
  v_and_b32 v30, 0xffff0000, v31
  v_mul_f32 v30, s52, v30
  v_cvt_pk_bf16_f32 v31, v30, v30
  v_and_b32 v30, 0xffff0000, v31
  s_waitcnt vmcnt(4)
  buffer_load_dwordx4 v[188:191], v5, s[28:31], s37 offen offset:3072 nt
  ds_write_b32 v42, v30
  v_add_u32 v42, 128, v42
  s_add_u32 s36, s70, s38
  s_add_u32 s37, s36, 4096
  s_add_u32 s38, s38, 32768
  s_waitcnt vmcnt(32)
  s_waitcnt vmcnt(4)
  buffer_load_dwordx4 v[192:195], v5, s[28:31], s36 offen offset:0 nt
  v_dot2_f32_bf16 v12, v224, v8, 0
  v_dot2_f32_bf16 v12, v225, v9, v12
  v_dot2_f32_bf16 v12, v226, v10, v12
  v_dot2_f32_bf16 v12, v227, v11, v12
  v_dot2_f32_bf16 v13, v228, v8, 0
  v_dot2_f32_bf16 v13, v229, v9, v13
  v_dot2_f32_bf16 v13, v230, v10, v13
  v_dot2_f32_bf16 v13, v231, v11, v13
  s_waitcnt vmcnt(4)
  buffer_load_dwordx4 v[196:199], v5, s[28:31], s36 offen offset:1024 nt
  v_dot2_f32_bf16 v14, v232, v8, 0
  v_dot2_f32_bf16 v14, v233, v9, v14
  v_dot2_f32_bf16 v14, v234, v10, v14
  v_dot2_f32_bf16 v14, v235, v11, v14
  v_dot2_f32_bf16 v15, v236, v8, 0
  v_dot2_f32_bf16 v15, v237, v9, v15
  v_dot2_f32_bf16 v15, v238, v10, v15
  v_dot2_f32_bf16 v15, v239, v11, v15
  s_waitcnt vmcnt(4)
  buffer_load_dwordx4 v[200:203], v5, s[28:31], s36 offen offset:2048 nt
  v_dot2_f32_bf16 v16, v240, v8, 0
  v_dot2_f32_bf16 v16, v241, v9, v16
  v_dot2_f32_bf16 v16, v242, v10, v16
  v_dot2_f32_bf16 v16, v243, v11, v16
  v_dot2_f32_bf16 v17, v244, v8, 0
  v_dot2_f32_bf16 v17, v245, v9, v17
  v_dot2_f32_bf16 v17, v246, v10, v17
  v_dot2_f32_bf16 v17, v247, v11, v17
  s_waitcnt vmcnt(4)
  buffer_load_dwordx4 v[204:207], v5, s[28:31], s36 offen offset:3072 nt
  v_dot2_f32_bf16 v18, v248, v8, 0
  v_dot2_f32_bf16 v18, v249, v9, v18
  v_dot2_f32_bf16 v18, v250, v10, v18
  v_dot2_f32_bf16 v18, v251, v11, v18
  v_dot2_f32_bf16 v19, v252, v8, 0
  v_dot2_f32_bf16 v19, v253, v9, v19
  v_dot2_f32_bf16 v19, v254, v10, v19
  v_dot2_f32_bf16 v19, v255, v11, v19
  s_waitcnt vmcnt(4)
  buffer_load_dwordx4 v[208:211], v5, s[28:31], s37 offen offset:0 nt
  v_add_f32_dpp v12, v12, v12 row_ror:8 row_mask:0xf bank_mask:0x3
  v_add_f32_dpp v14, v14, v14 row_ror:8 row_mask:0xf bank_mask:0x3
  v_add_f32_dpp v16, v16, v16 row_ror:8 row_mask:0xf bank_mask:0x3
  v_add_f32_dpp v18, v18, v18 row_ror:8 row_mask:0xf bank_mask:0x3
  v_add_f32_dpp v12, v13, v13 row_ror:8 row_mask:0xf bank_mask:0xc
  v_add_f32_dpp v14, v15, v15 row_ror:8 row_mask:0xf bank_mask:0xc
  v_add_f32_dpp v16, v17, v17 row_ror:8 row_mask:0xf bank_mask:0xc
  v_add_f32_dpp v18, v19, v19 row_ror:8 row_mask:0xf bank_mask:0xc
  s_waitcnt vmcnt(4)
  buffer_load_dwordx4 v[212:215], v5, s[28:31], s37 offen offset:1024 nt
  v_add_f32_dpp v12, v12, v12 row_half_mirror row_mask:0xf bank_mask:0x5
  v_add_f32_dpp v16, v16, v16 row_half_mirror row_mask:0xf bank_mask:0x5
  s_nop 0
  v_add_f32_dpp v12, v14, v14 row_half_mirror row_mask:0xf bank_mask:0xa
  v_add_f32_dpp v16, v18, v18 row_half_mirror row_mask:0xf bank_mask:0xa
  s_nop 0
  v_add_f32_dpp v31, v12, v12 quad_perm:[2,3,0,1] row_mask:0xf bank_mask:0xf
  v_add_f32_dpp v32, v16, v16 quad_perm:[2,3,0,1] row_mask:0xf bank_mask:0xf
  v_cndmask_b32 v30, v31, v32, s[50:51]
  s_nop 1
  v_add_f32_dpp v30, v30, v30 quad_perm:[1,0,3,2] row_mask:0xf bank_mask:0xf
  s_waitcnt vmcnt(4)
  buffer_load_dwordx4 v[216:219], v5, s[28:31], s37 offen offset:2048 nt
  v_cvt_pk_bf16_f32 v31, v30, v30
  v_and_b32 v30, 0xffff0000, v31
  v_mul_f32 v30, s52, v30
  v_cvt_pk_bf16_f32 v31, v30, v30
  v_and_b32 v30, 0xffff0000, v31
  s_waitcnt vmcnt(4)
  buffer_load_dwordx4 v[220:223], v5, s[28:31], s37 offen offset:3072 nt
  ds_write_b32 v42, v30
  v_add_u32 v42, 128, v42
  s_add_u32 s36, s71, s38
  s_add_u32 s37, s36, 4096
  s_add_u32 s38, s38, 32768
  s_waitcnt vmcnt(32)
  s_waitcnt vmcnt(4)
  buffer_load_dwordx4 v[224:227], v5, s[28:31], s36 offen offset:0 nt
  v_dot2_f32_bf16 v12, v64, v8, 0
  v_dot2_f32_bf16 v12, v65, v9, v12
  v_dot2_f32_bf16 v12, v66, v10, v12
  v_dot2_f32_bf16 v12, v67, v11, v12
  v_dot2_f32_bf16 v13, v68, v8, 0
  v_dot2_f32_bf16 v13, v69, v9, v13
  v_dot2_f32_bf16 v13, v70, v10, v13
  v_dot2_f32_bf16 v13, v71, v11, v13
  s_waitcnt vmcnt(4)
  buffer_load_dwordx4 v[228:231], v5, s[28:31], s36 offen offset:1024 nt
  v_dot2_f32_bf16 v14, v72, v8, 0
  v_dot2_f32_bf16 v14, v73, v9, v14
  v_dot2_f32_bf16 v14, v74, v10, v14
  v_dot2_f32_bf16 v14, v75, v11, v14
  v_dot2_f32_bf16 v15, v76, v8, 0
  v_dot2_f32_bf16 v15, v77, v9, v15
  v_dot2_f32_bf16 v15, v78, v10, v15
  v_dot2_f32_bf16 v15, v79, v11, v15
  s_waitcnt vmcnt(4)
  buffer_load_dwordx4 v[232:235], v5, s[28:31], s36 offen offset:2048 nt
  v_dot2_f32_bf16 v16, v80, v8, 0
  v_dot2_f32_bf16 v16, v81, v9, v16
  v_dot2_f32_bf16 v16, v82, v10, v16
  v_dot2_f32_bf16 v16, v83, v11, v16
  v_dot2_f32_bf16 v17, v84, v8, 0
  v_dot2_f32_bf16 v17, v85, v9, v17
  v_dot2_f32_bf16 v17, v86, v10, v17
  v_dot2_f32_bf16 v17, v87, v11, v17
  s_waitcnt vmcnt(4)
  buffer_load_dwordx4 v[236:239], v5, s[28:31], s36 offen offset:3072 nt
  v_dot2_f32_bf16 v18, v88, v8, 0
  v_dot2_f32_bf16 v18, v89, v9, v18
  v_dot2_f32_bf16 v18, v90, v10, v18
  v_dot2_f32_bf16 v18, v91, v11, v18
  v_dot2_f32_bf16 v19, v92, v8, 0
  v_dot2_f32_bf16 v19, v93, v9, v19
  v_dot2_f32_bf16 v19, v94, v10, v19
  v_dot2_f32_bf16 v19, v95, v11, v19
  s_waitcnt vmcnt(4)
  buffer_load_dwordx4 v[240:243], v5, s[28:31], s37 offen offset:0 nt
  v_add_f32_dpp v12, v12, v12 row_ror:8 row_mask:0xf bank_mask:0x3
  v_add_f32_dpp v14, v14, v14 row_ror:8 row_mask:0xf bank_mask:0x3
  v_add_f32_dpp v16, v16, v16 row_ror:8 row_mask:0xf bank_mask:0x3
  v_add_f32_dpp v18, v18, v18 row_ror:8 row_mask:0xf bank_mask:0x3
  v_add_f32_dpp v12, v13, v13 row_ror:8 row_mask:0xf bank_mask:0xc
  v_add_f32_dpp v14, v15, v15 row_ror:8 row_mask:0xf bank_mask:0xc
  v_add_f32_dpp v16, v17, v17 row_ror:8 row_mask:0xf bank_mask:0xc
  v_add_f32_dpp v18, v19, v19 row_ror:8 row_mask:0xf bank_mask:0xc
  s_waitcnt vmcnt(4)
  buffer_load_dwordx4 v[244:247], v5, s[28:31], s37 offen offset:1024 nt
  v_add_f32_dpp v12, v12, v12 row_half_mirror row_mask:0xf bank_mask:0x5
  v_add_f32_dpp v16, v16, v16 row_half_mirror row_mask:0xf bank_mask:0x5
  s_nop 0
  v_add_f32_dpp v12, v14, v14 row_half_mirror row_mask:0xf bank_mask:0xa
  v_add_f32_dpp v16, v18, v18 row_half_mirror row_mask:0xf bank_mask:0xa
  s_nop 0
  v_add_f32_dpp v31, v12, v12 quad_perm:[2,3,0,1] row_mask:0xf bank_mask:0xf
  v_add_f32_dpp v32, v16, v16 quad_perm:[2,3,0,1] row_mask:0xf bank_mask:0xf
  v_cndmask_b32 v30, v31, v32, s[50:51]
  s_nop 1
  v_add_f32_dpp v30, v30, v30 quad_perm:[1,0,3,2] row_mask:0xf bank_mask:0xf
  s_waitcnt vmcnt(4)
  buffer_load_dwordx4 v[248:251], v5, s[28:31], s37 offen offset:2048 nt
  v_cvt_pk_bf16_f32 v31, v30, v30
  v_and_b32 v30, 0xffff0000, v31
  v_mul_f32 v30, s52, v30
  v_cvt_pk_bf16_f32 v31, v30, v30
  v_and_b32 v30, 0xffff0000, v31
  s_waitcnt vmcnt(4)
  buffer_load_dwordx4 v[252:255], v5, s[28:31], s37 offen offset:3072 nt
  ds_write_b32 v42, v30
  v_add_u32 v42, 128, v42
  s_cmp_lt_u32 s38, 983040
  s_nop 3
  s_cbranch_scc1 A_kloop
  s_add_u32 s36, s70, 983040
  s_add_u32 s37, s36, 4096
  s_waitcnt vmcnt(32)
  s_waitcnt vmcnt(4)
  buffer_load_dwordx4 v[64:67], v5, s[28:31], s36 offen offset:0 nt
  v_dot2_f32_bf16 v12, v96, v8, 0
  v_dot2_f32_bf16 v12, v97, v9, v12
  v_dot2_f32_bf16 v12, v98, v10, v12
  v_dot2_f32_bf16 v12, v99, v11, v12
  v_dot2_f32_bf16 v13, v100, v8, 0
  v_dot2_f32_bf16 v13, v101, v9, v13
  v_dot2_f32_bf16 v13, v102, v10, v13
  v_dot2_f32_bf16 v13, v103, v11, v13
  s_waitcnt vmcnt(4)
  buffer_load_dwordx4 v[68:71], v5, s[28:31], s36 offen offset:1024 nt
  v_dot2_f32_bf16 v14, v104, v8, 0
  v_dot2_f32_bf16 v14, v105, v9, v14
  v_dot2_f32_bf16 v14, v106, v10, v14
  v_dot2_f32_bf16 v14, v107, v11, v14
  v_dot2_f32_bf16 v15, v108, v8, 0
  v_dot2_f32_bf16 v15, v109, v9, v15
  v_dot2_f32_bf16 v15, v110, v10, v15
  v_dot2_f32_bf16 v15, v111, v11, v15
  s_waitcnt vmcnt(4)
  buffer_load_dwordx4 v[72:75], v5, s[28:31], s36 offen offset:2048 nt
  v_dot2_f32_bf16 v16, v112, v8, 0
  v_dot2_f32_bf16 v16, v113, v9, v16
  v_dot2_f32_bf16 v16, v114, v10, v16
  v_dot2_f32_bf16 v16, v115, v11, v16
  v_dot2_f32_bf16 v17, v116, v8, 0
  v_dot2_f32_bf16 v17, v117, v9, v17
  v_dot2_f32_bf16 v17, v118, v10, v17
  v_dot2_f32_bf16 v17, v119, v11, v17
  s_waitcnt vmcnt(4)
  buffer_load_dwordx4 v[76:79], v5, s[28:31], s36 offen offset:3072 nt
  v_dot2_f32_bf16 v18, v120, v8, 0
  v_dot2_f32_bf16 v18, v121, v9, v18
  v_dot2_f32_bf16 v18, v122, v10, v18
  v_dot2_f32_bf16 v18, v123, v11, v18
  v_dot2_f32_bf16 v19, v124, v8, 0
  v_dot2_f32_bf16 v19, v125, v9, v19
  v_dot2_f32_bf16 v19, v126, v10, v19
  v_dot2_f32_bf16 v19, v127, v11, v19
  s_waitcnt vmcnt(4)
  buffer_load_dwordx4 v[80:83], v5, s[28:31], s37 offen offset:0 nt
  v_add_f32_dpp v12, v12, v12 row_ror:8 row_mask:0xf bank_mask:0x3
  v_add_f32_dpp v14, v14, v14 row_ror:8 row_mask:0xf bank_mask:0x3
  v_add_f32_dpp v16, v16, v16 row_ror:8 row_mask:0xf bank_mask:0x3
  v_add_f32_dpp v18, v18, v18 row_ror:8 row_mask:0xf bank_mask:0x3
  v_add_f32_dpp v12, v13, v13 row_ror:8 row_mask:0xf bank_mask:0xc
  v_add_f32_dpp v14, v15, v15 row_ror:8 row_mask:0xf bank_mask:0xc
  v_add_f32_dpp v16, v17, v17 row_ror:8 row_mask:0xf bank_mask:0xc
  v_add_f32_dpp v18, v19, v19 row_ror:8 row_mask:0xf bank_mask:0xc
  s_waitcnt vmcnt(4)
  buffer_load_dwordx4 v[84:87], v5, s[28:31], s37 offen offset:1024 nt
  v_add_f32_dpp v12, v12, v12 row_half_mirror row_mask:0xf bank_mask:0x5
  v_add_f32_dpp v16, v16, v16 row_half_mirror row_mask:0xf bank_mask:0x5
  s_nop 0
  v_add_f32_dpp v12, v14, v14 row_half_mirror row_mask:0xf bank_mask:0xa
  v_add_f32_dpp v16, v18, v18 row_half_mirror row_mask:0xf bank_mask:0xa
  s_nop 0
  v_add_f32_dpp v31, v12, v12 quad_perm:[2,3,0,1] row_mask:0xf bank_mask:0xf
  v_add_f32_dpp v32, v16, v16 quad_perm:[2,3,0,1] row_mask:0xf bank_mask:0xf
  v_cndmask_b32 v30, v31, v32, s[50:51]
  s_nop 1
  v_add_f32_dpp v30, v30, v30 quad_perm:[1,0,3,2] row_mask:0xf bank_mask:0xf
  s_waitcnt vmcnt(4)
  buffer_load_dwordx4 v[88:91], v5, s[28:31], s37 offen offset:2048 nt
  v_cvt_pk_bf16_f32 v31, v30, v30
  v_and_b32 v30, 0xffff0000, v31
  v_mul_f32 v30, s52, v30
  v_cvt_pk_bf16_f32 v31, v30, v30
  v_and_b32 v30, 0xffff0000, v31
  s_waitcnt vmcnt(4)
  buffer_load_dwordx4 v[92:95], v5, s[28:31], s37 offen offset:3072 nt
  ds_write_b32 v42, v30
  v_add_u32 v42, 128, v42
  s_add_u32 s36, s71, 1015808
  s_add_u32 s37, s36, 4096
  s_waitcnt vmcnt(32)
  s_waitcnt vmcnt(4)
  buffer_load_dwordx4 v[96:99], v5, s[28:31], s36 offen offset:0 nt
  v_dot2_f32_bf16 v12, v128, v8, 0
  v_dot2_f32_bf16 v12, v129, v9, v12
  v_dot2_f32_bf16 v12, v130, v10, v12
  v_dot2_f32_bf16 v12, v131, v11, v12
  v_dot2_f32_bf16 v13, v132, v8, 0
  v_dot2_f32_bf16 v13, v133, v9, v13
  v_dot2_f32_bf16 v13, v134, v10, v13
  v_dot2_f32_bf16 v13, v135, v11, v13
  s_waitcnt vmcnt(4)
  buffer_load_dwordx4 v[100:103], v5, s[28:31], s36 offen offset:1024 nt
  v_dot2_f32_bf16 v14, v136, v8, 0
  v_dot2_f32_bf16 v14, v137, v9, v14
  v_dot2_f32_bf16 v14, v138, v10, v14
  v_dot2_f32_bf16 v14, v139, v11, v14
  v_dot2_f32_bf16 v15, v140, v8, 0
  v_dot2_f32_bf16 v15, v141, v9, v15
  v_dot2_f32_bf16 v15, v142, v10, v15
  v_dot2_f32_bf16 v15, v143, v11, v15
  s_waitcnt vmcnt(4)
  buffer_load_dwordx4 v[104:107], v5, s[28:31], s36 offen offset:2048 nt
  v_dot2_f32_bf16 v16, v144, v8, 0
  v_dot2_f32_bf16 v16, v145, v9, v16
  v_dot2_f32_bf16 v16, v146, v10, v16
  v_dot2_f32_bf16 v16, v147, v11, v16
  v_dot2_f32_bf16 v17, v148, v8, 0
  v_dot2_f32_bf16 v17, v149, v9, v17
  v_dot2_f32_bf16 v17, v150, v10, v17
  v_dot2_f32_bf16 v17, v151, v11, v17
  s_waitcnt vmcnt(4)
  buffer_load_dwordx4 v[108:111], v5, s[28:31], s36 offen offset:3072 nt
  v_dot2_f32_bf16 v18, v152, v8, 0
  v_dot2_f32_bf16 v18, v153, v9, v18
  v_dot2_f32_bf16 v18, v154, v10, v18
  v_dot2_f32_bf16 v18, v155, v11, v18
  v_dot2_f32_bf16 v19, v156, v8, 0
  v_dot2_f32_bf16 v19, v157, v9, v19
  v_dot2_f32_bf16 v19, v158, v10, v19
  v_dot2_f32_bf16 v19, v159, v11, v19
  s_waitcnt vmcnt(4)
  buffer_load_dwordx4 v[112:115], v5, s[28:31], s37 offen offset:0 nt
  v_add_f32_dpp v12, v12, v12 row_ror:8 row_mask:0xf bank_mask:0x3
  v_add_f32_dpp v14, v14, v14 row_ror:8 row_mask:0xf bank_mask:0x3
  v_add_f32_dpp v16, v16, v16 row_ror:8 row_mask:0xf bank_mask:0x3
  v_add_f32_dpp v18, v18, v18 row_ror:8 row_mask:0xf bank_mask:0x3
  v_add_f32_dpp v12, v13, v13 row_ror:8 row_mask:0xf bank_mask:0xc
  v_add_f32_dpp v14, v15, v15 row_ror:8 row_mask:0xf bank_mask:0xc
  v_add_f32_dpp v16, v17, v17 row_ror:8 row_mask:0xf bank_mask:0xc
  v_add_f32_dpp v18, v19, v19 row_ror:8 row_mask:0xf bank_mask:0xc
  s_waitcnt vmcnt(4)
  buffer_load_dwordx4 v[116:119], v5, s[28:31], s37 offen offset:1024 nt
  v_add_f32_dpp v12, v12, v12 row_half_mirror row_mask:0xf bank_mask:0x5
  v_add_f32_dpp v16, v16, v16 row_half_mirror row_mask:0xf bank_mask:0x5
  s_nop 0
  v_add_f32_dpp v12, v14, v14 row_half_mirror row_mask:0xf bank_mask:0xa
  v_add_f32_dpp v16, v18, v18 row_half_mirror row_mask:0xf bank_mask:0xa
  s_nop 0
  v_add_f32_dpp v31, v12, v12 quad_perm:[2,3,0,1] row_mask:0xf bank_mask:0xf
  v_add_f32_dpp v32, v16, v16 quad_perm:[2,3,0,1] row_mask:0xf bank_mask:0xf
  v_cndmask_b32 v30, v31, v32, s[50:51]
  s_nop 1
  v_add_f32_dpp v30, v30, v30 quad_perm:[1,0,3,2] row_mask:0xf bank_mask:0xf
  s_waitcnt vmcnt(4)
  buffer_load_dwordx4 v[120:123], v5, s[28:31], s37 offen offset:2048 nt
  v_cvt_pk_bf16_f32 v31, v30, v30
  v_and_b32 v30, 0xffff0000, v31
  v_mul_f32 v30, s52, v30
  v_cvt_pk_bf16_f32 v31, v30, v30
  v_and_b32 v30, 0xffff0000, v31
  s_waitcnt vmcnt(4)
  buffer_load_dwordx4 v[124:127], v5, s[28:31], s37 offen offset:3072 nt
  ds_write_b32 v42, v30
  v_add_u32 v42, 128, v42
  s_add_u32 s36, s70, 0
  s_add_u32 s37, s36, 4096
  s_waitcnt vmcnt(32)
  s_waitcnt vmcnt(4)
  buffer_load_dwordx4 v[128:131], v5, s[32:35], s36 offen offset:0 nt
  v_dot2_f32_bf16 v12, v160, v8, 0
  v_dot2_f32_bf16 v12, v161, v9, v12
  v_dot2_f32_bf16 v12, v162, v10, v12
  v_dot2_f32_bf16 v12, v163, v11, v12
  v_dot2_f32_bf16 v13, v164, v8, 0
  v_dot2_f32_bf16 v13, v165, v9, v13
  v_dot2_f32_bf16 v13, v166, v10, v13
  v_dot2_f32_bf16 v13, v167, v11, v13
  s_waitcnt vmcnt(4)
  buffer_load_dwordx4 v[132:135], v5, s[32:35], s36 offen offset:1024 nt
  v_dot2_f32_bf16 v14, v168, v8, 0
  v_dot2_f32_bf16 v14, v169, v9, v14
  v_dot2_f32_bf16 v14, v170, v10, v14
  v_dot2_f32_bf16 v14, v171, v11, v14
  v_dot2_f32_bf16 v15, v172, v8, 0
  v_dot2_f32_bf16 v15, v173, v9, v15
  v_dot2_f32_bf16 v15, v174, v10, v15
  v_dot2_f32_bf16 v15, v175, v11, v15
  s_waitcnt vmcnt(4)
  buffer_load_dwordx4 v[136:139], v5, s[32:35], s36 offen offset:2048 nt
  v_dot2_f32_bf16 v16, v176, v8, 0
  v_dot2_f32_bf16 v16, v177, v9, v16
  v_dot2_f32_bf16 v16, v178, v10, v16
  v_dot2_f32_bf16 v16, v179, v11, v16
  v_dot2_f32_bf16 v17, v180, v8, 0
  v_dot2_f32_bf16 v17, v181, v9, v17
  v_dot2_f32_bf16 v17, v182, v10, v17
  v_dot2_f32_bf16 v17, v183, v11, v17
  s_waitcnt vmcnt(4)
  buffer_load_dwordx4 v[140:143], v5, s[32:35], s36 offen offset:3072 nt
  v_dot2_f32_bf16 v18, v184, v8, 0
  v_dot2_f32_bf16 v18, v185, v9, v18
  v_dot2_f32_bf16 v18, v186, v10, v18
  v_dot2_f32_bf16 v18, v187, v11, v18
  v_dot2_f32_bf16 v19, v188, v8, 0
  v_dot2_f32_bf16 v19, v189, v9, v19
  v_dot2_f32_bf16 v19, v190, v10, v19
  v_dot2_f32_bf16 v19, v191, v11, v19
  s_waitcnt vmcnt(4)
  buffer_load_dwordx4 v[144:147], v5, s[32:35], s37 offen offset:0 nt
  v_add_f32_dpp v12, v12, v12 row_ror:8 row_mask:0xf bank_mask:0x3
  v_add_f32_dpp v14, v14, v14 row_ror:8 row_mask:0xf bank_mask:0x3
  v_add_f32_dpp v16, v16, v16 row_ror:8 row_mask:0xf bank_mask:0x3
  v_add_f32_dpp v18, v18, v18 row_ror:8 row_mask:0xf bank_mask:0x3
  v_add_f32_dpp v12, v13, v13 row_ror:8 row_mask:0xf bank_mask:0xc
  v_add_f32_dpp v14, v15, v15 row_ror:8 row_mask:0xf bank_mask:0xc
  v_add_f32_dpp v16, v17, v17 row_ror:8 row_mask:0xf bank_mask:0xc
  v_add_f32_dpp v18, v19, v19 row_ror:8 row_mask:0xf bank_mask:0xc
  s_waitcnt vmcnt(4)
  buffer_load_dwordx4 v[148:151], v5, s[32:35], s37 offen offset:1024 nt
  v_add_f32_dpp v12, v12, v12 row_half_mirror row_mask:0xf bank_mask:0x5
  v_add_f32_dpp v16, v16, v16 row_half_mirror row_mask:0xf bank_mask:0x5
  s_nop 0
  v_add_f32_dpp v12, v14, v14 row_half_mirror row_mask:0xf bank_mask:0xa
  v_add_f32_dpp v16, v18, v18 row_half_mirror row_mask:0xf bank_mask:0xa
  s_nop 0
  v_add_f32_dpp v31, v12, v12 quad_perm:[2,3,0,1] row_mask:0xf bank_mask:0xf
  v_add_f32_dpp v32, v16, v16 quad_perm:[2,3,0,1] row_mask:0xf bank_mask:0xf
  v_cndmask_b32 v30, v31, v32, s[50:51]
  s_nop 1
  v_add_f32_dpp v30, v30, v30 quad_perm:[1,0,3,2] row_mask:0xf bank_mask:0xf
  s_waitcnt vmcnt(4)
  buffer_load_dwordx4 v[152:155], v5, s[32:35], s37 offen offset:2048 nt
  v_cvt_pk_bf16_f32 v31, v30, v30
  v_and_b32 v30, 0xffff0000, v31
  v_mul_f32 v30, s52, v30
  v_cvt_pk_bf16_f32 v31, v30, v30
  v_and_b32 v30, 0xffff0000, v31
  s_waitcnt vmcnt(4)
  buffer_load_dwordx4 v[156:159], v5, s[32:35], s37 offen offset:3072 nt
  ds_write_b32 v42, v30
  v_add_u32 v42, 128, v42
  s_add_u32 s36, s71, 32768
  s_add_u32 s37, s36, 4096
  s_waitcnt vmcnt(32)
  s_waitcnt vmcnt(4)
  buffer_load_dwordx4 v[160:163], v5, s[32:35], s36 offen offset:0 nt
  v_dot2_f32_bf16 v12, v192, v8, 0
  v_dot2_f32_bf16 v12, v193, v9, v12
  v_dot2_f32_bf16 v12, v194, v10, v12
  v_dot2_f32_bf16 v12, v195, v11, v12
  v_dot2_f32_bf16 v13, v196, v8, 0
  v_dot2_f32_bf16 v13, v197, v9, v13
  v_dot2_f32_bf16 v13, v198, v10, v13
  v_dot2_f32_bf16 v13, v199, v11, v13
  s_waitcnt vmcnt(4)
  buffer_load_dwordx4 v[164:167], v5, s[32:35], s36 offen offset:1024 nt
  v_dot2_f32_bf16 v14, v200, v8, 0
  v_dot2_f32_bf16 v14, v201, v9, v14
  v_dot2_f32_bf16 v14, v202, v10, v14
  v_dot2_f32_bf16 v14, v203, v11, v14
  v_dot2_f32_bf16 v15, v204, v8, 0
  v_dot2_f32_bf16 v15, v205, v9, v15
  v_dot2_f32_bf16 v15, v206, v10, v15
  v_dot2_f32_bf16 v15, v207, v11, v15
  s_waitcnt vmcnt(4)
  buffer_load_dwordx4 v[168:171], v5, s[32:35], s36 offen offset:2048 nt
  v_dot2_f32_bf16 v16, v208, v8, 0
  v_dot2_f32_bf16 v16, v209, v9, v16
  v_dot2_f32_bf16 v16, v210, v10, v16
  v_dot2_f32_bf16 v16, v211, v11, v16
  v_dot2_f32_bf16 v17, v212, v8, 0
  v_dot2_f32_bf16 v17, v213, v9, v17
  v_dot2_f32_bf16 v17, v214, v10, v17
  v_dot2_f32_bf16 v17, v215, v11, v17
  s_waitcnt vmcnt(4)
  buffer_load_dwordx4 v[172:175], v5, s[32:35], s36 offen offset:3072 nt
  v_dot2_f32_bf16 v18, v216, v8, 0
  v_dot2_f32_bf16 v18, v217, v9, v18
  v_dot2_f32_bf16 v18, v218, v10, v18
  v_dot2_f32_bf16 v18, v219, v11, v18
  v_dot2_f32_bf16 v19, v220, v8, 0
  v_dot2_f32_bf16 v19, v221, v9, v19
  v_dot2_f32_bf16 v19, v222, v10, v19
  v_dot2_f32_bf16 v19, v223, v11, v19
  s_waitcnt vmcnt(4)
  buffer_load_dwordx4 v[176:179], v5, s[32:35], s37 offen offset:0 nt
  v_add_f32_dpp v12, v12, v12 row_ror:8 row_mask:0xf bank_mask:0x3
  v_add_f32_dpp v14, v14, v14 row_ror:8 row_mask:0xf bank_mask:0x3
  v_add_f32_dpp v16, v16, v16 row_ror:8 row_mask:0xf bank_mask:0x3
  v_add_f32_dpp v18, v18, v18 row_ror:8 row_mask:0xf bank_mask:0x3
  v_add_f32_dpp v12, v13, v13 row_ror:8 row_mask:0xf bank_mask:0xc
  v_add_f32_dpp v14, v15, v15 row_ror:8 row_mask:0xf bank_mask:0xc
  v_add_f32_dpp v16, v17, v17 row_ror:8 row_mask:0xf bank_mask:0xc
  v_add_f32_dpp v18, v19, v19 row_ror:8 row_mask:0xf bank_mask:0xc
  s_waitcnt vmcnt(4)
  buffer_load_dwordx4 v[180:183], v5, s[32:35], s37 offen offset:1024 nt
  v_add_f32_dpp v12, v12, v12 row_half_mirror row_mask:0xf bank_mask:0x5
  v_add_f32_dpp v16, v16, v16 row_half_mirror row_mask:0xf bank_mask:0x5
  s_nop 0
  v_add_f32_dpp v12, v14, v14 row_half_mirror row_mask:0xf bank_mask:0xa
  v_add_f32_dpp v16, v18, v18 row_half_mirror row_mask:0xf bank_mask:0xa
  s_nop 0
  v_add_f32_dpp v31, v12, v12 quad_perm:[2,3,0,1] row_mask:0xf bank_mask:0xf
  v_add_f32_dpp v32, v16, v16 quad_perm:[2,3,0,1] row_mask:0xf bank_mask:0xf
  v_cndmask_b32 v30, v31, v32, s[50:51]
  s_nop 1
  v_add_f32_dpp v30, v30, v30 quad_perm:[1,0,3,2] row_mask:0xf bank_mask:0xf
  s_waitcnt vmcnt(4)
  buffer_load_dwordx4 v[184:187], v5, s[32:35], s37 offen offset:2048 nt
  v_cvt_pk_bf16_f32 v31, v30, v30
  v_and_b32 v30, 0xffff0000, v31
  v_mul_f32 v30, s52, v30
  v_cvt_pk_bf16_f32 v31, v30, v30
  v_and_b32 v30, 0xffff0000, v31
  s_waitcnt vmcnt(4)
  buffer_load_dwordx4 v[188:191], v5, s[32:35], s37 offen offset:3072 nt
  ds_write_b32 v42, v30
  v_add_u32 v42, 128, v42
  s_add_u32 s36, s70, 65536
  s_add_u32 s37, s36, 4096
  s_waitcnt vmcnt(32)
  s_waitcnt vmcnt(4)
  buffer_load_dwordx4 v[192:195], v5, s[32:35], s36 offen offset:0 nt
  v_dot2_f32_bf16 v12, v224, v8, 0
  v_dot2_f32_bf16 v12, v225, v9, v12
  v_dot2_f32_bf16 v12, v226, v10, v12
  v_dot2_f32_bf16 v12, v227, v11, v12
  v_dot2_f32_bf16 v13, v228, v8, 0
  v_dot2_f32_bf16 v13, v229, v9, v13
  v_dot2_f32_bf16 v13, v230, v10, v13
  v_dot2_f32_bf16 v13, v231, v11, v13
  s_waitcnt vmcnt(4)
  buffer_load_dwordx4 v[196:199], v5, s[32:35], s36 offen offset:1024 nt
  v_dot2_f32_bf16 v14, v232, v8, 0
  v_dot2_f32_bf16 v14, v233, v9, v14
  v_dot2_f32_bf16 v14, v234, v10, v14
  v_dot2_f32_bf16 v14, v235, v11, v14
  v_dot2_f32_bf16 v15, v236, v8, 0
  v_dot2_f32_bf16 v15, v237, v9, v15
  v_dot2_f32_bf16 v15, v238, v10, v15
  v_dot2_f32_bf16 v15, v239, v11, v15
  s_waitcnt vmcnt(4)
  buffer_load_dwordx4 v[200:203], v5, s[32:35], s36 offen offset:2048 nt
  v_dot2_f32_bf16 v16, v240, v8, 0
  v_dot2_f32_bf16 v16, v241, v9, v16
  v_dot2_f32_bf16 v16, v242, v10, v16
  v_dot2_f32_bf16 v16, v243, v11, v16
  v_dot2_f32_bf16 v17, v244, v8, 0
  v_dot2_f32_bf16 v17, v245, v9, v17
  v_dot2_f32_bf16 v17, v246, v10, v17
  v_dot2_f32_bf16 v17, v247, v11, v17
  s_waitcnt vmcnt(4)
  buffer_load_dwordx4 v[204:207], v5, s[32:35], s36 offen offset:3072 nt
  v_dot2_f32_bf16 v18, v248, v8, 0
  v_dot2_f32_bf16 v18, v249, v9, v18
  v_dot2_f32_bf16 v18, v250, v10, v18
  v_dot2_f32_bf16 v18, v251, v11, v18
  v_dot2_f32_bf16 v19, v252, v8, 0
  v_dot2_f32_bf16 v19, v253, v9, v19
  v_dot2_f32_bf16 v19, v254, v10, v19
  v_dot2_f32_bf16 v19, v255, v11, v19
  s_waitcnt vmcnt(4)
  buffer_load_dwordx4 v[208:211], v5, s[32:35], s37 offen offset:0 nt
  v_add_f32_dpp v12, v12, v12 row_ror:8 row_mask:0xf bank_mask:0x3
  v_add_f32_dpp v14, v14, v14 row_ror:8 row_mask:0xf bank_mask:0x3
  v_add_f32_dpp v16, v16, v16 row_ror:8 row_mask:0xf bank_mask:0x3
  v_add_f32_dpp v18, v18, v18 row_ror:8 row_mask:0xf bank_mask:0x3
  v_add_f32_dpp v12, v13, v13 row_ror:8 row_mask:0xf bank_mask:0xc
  v_add_f32_dpp v14, v15, v15 row_ror:8 row_mask:0xf bank_mask:0xc
  v_add_f32_dpp v16, v17, v17 row_ror:8 row_mask:0xf bank_mask:0xc
  v_add_f32_dpp v18, v19, v19 row_ror:8 row_mask:0xf bank_mask:0xc
  s_waitcnt vmcnt(4)
  buffer_load_dwordx4 v[212:215], v5, s[32:35], s37 offen offset:1024 nt
  v_add_f32_dpp v12, v12, v12 row_half_mirror row_mask:0xf bank_mask:0x5
  v_add_f32_dpp v16, v16, v16 row_half_mirror row_mask:0xf bank_mask:0x5
  s_nop 0
  v_add_f32_dpp v12, v14, v14 row_half_mirror row_mask:0xf bank_mask:0xa
  v_add_f32_dpp v16, v18, v18 row_half_mirror row_mask:0xf bank_mask:0xa
  s_nop 0
  v_add_f32_dpp v31, v12, v12 quad_perm:[2,3,0,1] row_mask:0xf bank_mask:0xf
  v_add_f32_dpp v32, v16, v16 quad_perm:[2,3,0,1] row_mask:0xf bank_mask:0xf
  v_cndmask_b32 v30, v31, v32, s[50:51]
  s_nop 1
  v_add_f32_dpp v30, v30, v30 quad_perm:[1,0,3,2] row_mask:0xf bank_mask:0xf
  s_waitcnt vmcnt(4)
  buffer_load_dwordx4 v[216:219], v5, s[32:35], s37 offen offset:2048 nt
  v_cvt_pk_bf16_f32 v31, v30, v30
  v_and_b32 v30, 0xffff0000, v31
  v_mul_f32 v30, s52, v30
  v_cvt_pk_bf16_f32 v31, v30, v30
  v_and_b32 v30, 0xffff0000, v31
  s_waitcnt vmcnt(4)
  buffer_load_dwordx4 v[220:223], v5, s[32:35], s37 offen offset:3072 nt
  ds_write_b32 v42, v30
  v_add_u32 v42, 128, v42
  s_add_u32 s36, s71, 98304
  s_add_u32 s37, s36, 4096
  s_waitcnt vmcnt(32)
  s_waitcnt vmcnt(4)
  buffer_load_dwordx4 v[224:227], v5, s[32:35], s36 offen offset:0 nt
  v_dot2_f32_bf16 v12, v64, v8, 0
  v_dot2_f32_bf16 v12, v65, v9, v12
  v_dot2_f32_bf16 v12, v66, v10, v12
  v_dot2_f32_bf16 v12, v67, v11, v12
  v_dot2_f32_bf16 v13, v68, v8, 0
  v_dot2_f32_bf16 v13, v69, v9, v13
  v_dot2_f32_bf16 v13, v70, v10, v13
  v_dot2_f32_bf16 v13, v71, v11, v13
  s_waitcnt vmcnt(4)
  buffer_load_dwordx4 v[228:231], v5, s[32:35], s36 offen offset:1024 nt
  v_dot2_f32_bf16 v14, v72, v8, 0
  v_dot2_f32_bf16 v14, v73, v9, v14
  v_dot2_f32_bf16 v14, v74, v10, v14
  v_dot2_f32_bf16 v14, v75, v11, v14
  v_dot2_f32_bf16 v15, v76, v8, 0
  v_dot2_f32_bf16 v15, v77, v9, v15
  v_dot2_f32_bf16 v15, v78, v10, v15
  v_dot2_f32_bf16 v15, v79, v11, v15
  s_waitcnt vmcnt(4)
  buffer_load_dwordx4 v[232:235], v5, s[32:35], s36 offen offset:2048 nt
  v_dot2_f32_bf16 v16, v80, v8, 0
  v_dot2_f32_bf16 v16, v81, v9, v16
  v_dot2_f32_bf16 v16, v82, v10, v16
  v_dot2_f32_bf16 v16, v83, v11, v16
  v_dot2_f32_bf16 v17, v84, v8, 0
  v_dot2_f32_bf16 v17, v85, v9, v17
  v_dot2_f32_bf16 v17, v86, v10, v17
  v_dot2_f32_bf16 v17, v87, v11, v17
  s_waitcnt vmcnt(4)
  buffer_load_dwordx4 v[236:239], v5, s[32:35], s36 offen offset:3072 nt
  v_dot2_f32_bf16 v18, v88, v8, 0
  v_dot2_f32_bf16 v18, v89, v9, v18
  v_dot2_f32_bf16 v18, v90, v10, v18
  v_dot2_f32_bf16 v18, v91, v11, v18
  v_dot2_f32_bf16 v19, v92, v8, 0
  v_dot2_f32_bf16 v19, v93, v9, v19
  v_dot2_f32_bf16 v19, v94, v10, v19
  v_dot2_f32_bf16 v19, v95, v11, v19
  s_waitcnt vmcnt(4)
  buffer_load_dwordx4 v[240:243], v5, s[32:35], s37 offen offset:0 nt
  v_add_f32_dpp v12, v12, v12 row_ror:8 row_mask:0xf bank_mask:0x3
  v_add_f32_dpp v14, v14, v14 row_ror:8 row_mask:0xf bank_mask:0x3
  v_add_f32_dpp v16, v16, v16 row_ror:8 row_mask:0xf bank_mask:0x3
  v_add_f32_dpp v18, v18, v18 row_ror:8 row_mask:0xf bank_mask:0x3
  v_add_f32_dpp v12, v13, v13 row_ror:8 row_mask:0xf bank_mask:0xc
  v_add_f32_dpp v14, v15, v15 row_ror:8 row_mask:0xf bank_mask:0xc
  v_add_f32_dpp v16, v17, v17 row_ror:8 row_mask:0xf bank_mask:0xc
  v_add_f32_dpp v18, v19, v19 row_ror:8 row_mask:0xf bank_mask:0xc
  s_waitcnt vmcnt(4)
  buffer_load_dwordx4 v[244:247], v5, s[32:35], s37 offen offset:1024 nt
  v_add_f32_dpp v12, v12, v12 row_half_mirror row_mask:0xf bank_mask:0x5
  v_add_f32_dpp v16, v16, v16 row_half_mirror row_mask:0xf bank_mask:0x5
  s_nop 0
  v_add_f32_dpp v12, v14, v14 row_half_mirror row_mask:0xf bank_mask:0xa
  v_add_f32_dpp v16, v18, v18 row_half_mirror row_mask:0xf bank_mask:0xa
  s_nop 0
  v_add_f32_dpp v31, v12, v12 quad_perm:[2,3,0,1] row_mask:0xf bank_mask:0xf
  v_add_f32_dpp v32, v16, v16 quad_perm:[2,3,0,1] row_mask:0xf bank_mask:0xf
  v_cndmask_b32 v30, v31, v32, s[50:51]
  s_nop 1
  v_add_f32_dpp v30, v30, v30 quad_perm:[1,0,3,2] row_mask:0xf bank_mask:0xf
  s_waitcnt vmcnt(4)
  buffer_load_dwordx4 v[248:251], v5, s[32:35], s37 offen offset:2048 nt
  v_cvt_pk_bf16_f32 v31, v30, v30
  v_and_b32 v30, 0xffff0000, v31
  v_mul_f32 v30, s52, v30
  v_cvt_pk_bf16_f32 v31, v30, v30
  v_and_b32 v30, 0xffff0000, v31
  s_waitcnt vmcnt(4)
  buffer_load_dwordx4 v[252:255], v5, s[32:35], s37 offen offset:3072 nt
  ds_write_b32 v42, v30
  v_add_u32 v42, 128, v42
  s_add_u32 s36, s70, 131072
  s_add_u32 s37, s36, 4096
  s_waitcnt vmcnt(32)
  s_waitcnt vmcnt(4)
  buffer_load_dwordx4 v[64:67], v5, s[32:35], s36 offen offset:0 nt
  v_dot2_f32_bf16 v12, v96, v8, 0
  v_dot2_f32_bf16 v12, v97, v9, v12
  v_dot2_f32_bf16 v12, v98, v10, v12
  v_dot2_f32_bf16 v12, v99, v11, v12
  v_dot2_f32_bf16 v13, v100, v8, 0
  v_dot2_f32_bf16 v13, v101, v9, v13
  v_dot2_f32_bf16 v13, v102, v10, v13
  v_dot2_f32_bf16 v13, v103, v11, v13
  s_waitcnt vmcnt(4)
  buffer_load_dwordx4 v[68:71], v5, s[32:35], s36 offen offset:1024 nt
  v_dot2_f32_bf16 v14, v104, v8, 0
  v_dot2_f32_bf16 v14, v105, v9, v14
  v_dot2_f32_bf16 v14, v106, v10, v14
  v_dot2_f32_bf16 v14, v107, v11, v14
  v_dot2_f32_bf16 v15, v108, v8, 0
  v_dot2_f32_bf16 v15, v109, v9, v15
  v_dot2_f32_bf16 v15, v110, v10, v15
  v_dot2_f32_bf16 v15, v111, v11, v15
  s_waitcnt vmcnt(4)
  buffer_load_dwordx4 v[72:75], v5, s[32:35], s36 offen offset:2048 nt
  v_dot2_f32_bf16 v16, v112, v8, 0
  v_dot2_f32_bf16 v16, v113, v9, v16
  v_dot2_f32_bf16 v16, v114, v10, v16
  v_dot2_f32_bf16 v16, v115, v11, v16
  v_dot2_f32_bf16 v17, v116, v8, 0
  v_dot2_f32_bf16 v17, v117, v9, v17
  v_dot2_f32_bf16 v17, v118, v10, v17
  v_dot2_f32_bf16 v17, v119, v11, v17
  s_waitcnt vmcnt(4)
  buffer_load_dwordx4 v[76:79], v5, s[32:35], s36 offen offset:3072 nt
  v_dot2_f32_bf16 v18, v120, v8, 0
  v_dot2_f32_bf16 v18, v121, v9, v18
  v_dot2_f32_bf16 v18, v122, v10, v18
  v_dot2_f32_bf16 v18, v123, v11, v18
  v_dot2_f32_bf16 v19, v124, v8, 0
  v_dot2_f32_bf16 v19, v125, v9, v19
  v_dot2_f32_bf16 v19, v126, v10, v19
  v_dot2_f32_bf16 v19, v127, v11, v19
  s_waitcnt vmcnt(4)
  buffer_load_dwordx4 v[80:83], v5, s[32:35], s37 offen offset:0 nt
  v_add_f32_dpp v12, v12, v12 row_ror:8 row_mask:0xf bank_mask:0x3
  v_add_f32_dpp v14, v14, v14 row_ror:8 row_mask:0xf bank_mask:0x3
  v_add_f32_dpp v16, v16, v16 row_ror:8 row_mask:0xf bank_mask:0x3
  v_add_f32_dpp v18, v18, v18 row_ror:8 row_mask:0xf bank_mask:0x3
  v_add_f32_dpp v12, v13, v13 row_ror:8 row_mask:0xf bank_mask:0xc
  v_add_f32_dpp v14, v15, v15 row_ror:8 row_mask:0xf bank_mask:0xc
  v_add_f32_dpp v16, v17, v17 row_ror:8 row_mask:0xf bank_mask:0xc
  v_add_f32_dpp v18, v19, v19 row_ror:8 row_mask:0xf bank_mask:0xc
  s_waitcnt vmcnt(4)
  buffer_load_dwordx4 v[84:87], v5, s[32:35], s37 offen offset:1024 nt
  v_add_f32_dpp v12, v12, v12 row_half_mirror row_mask:0xf bank_mask:0x5
  v_add_f32_dpp v16, v16, v16 row_half_mirror row_mask:0xf bank_mask:0x5
  s_nop 0
  v_add_f32_dpp v12, v14, v14 row_half_mirror row_mask:0xf bank_mask:0xa
  v_add_f32_dpp v16, v18, v18 row_half_mirror row_mask:0xf bank_mask:0xa
  s_nop 0
  v_add_f32_dpp v31, v12, v12 quad_perm:[2,3,0,1] row_mask:0xf bank_mask:0xf
  v_add_f32_dpp v32, v16, v16 quad_perm:[2,3,0,1] row_mask:0xf bank_mask:0xf
  v_cndmask_b32 v30, v31, v32, s[50:51]
  s_nop 1
  v_add_f32_dpp v30, v30, v30 quad_perm:[1,0,3,2] row_mask:0xf bank_mask:0xf
  s_waitcnt vmcnt(4)
  buffer_load_dwordx4 v[88:91], v5, s[32:35], s37 offen offset:2048 nt
  v_cvt_pk_bf16_f32 v31, v30, v30
  v_and_b32 v30, 0xffff0000, v31
  v_mul_f32 v30, s52, v30
  v_cvt_pk_bf16_f32 v31, v30, v30
  v_and_b32 v30, 0xffff0000, v31
  s_waitcnt vmcnt(4)
  buffer_load_dwordx4 v[92:95], v5, s[32:35], s37 offen offset:3072 nt
  ds_write_b32 v42, v30
  v_add_u32 v42, 128, v42
  v_mov_b32 v42, v41
  s_mov_b32 s38, 163840
  s_nop 3
A_vloop:
  ds_write_b32 v60, v40 offset:32
  v_add_u32 v40, 3, v40
  s_add_u32 s36, s71, s38
  s_add_u32 s37, s36, 4096
  s_add_u32 s38, s38, 32768
  ds_read_b32 v30, v42
  v_add_u32 v42, 128, v42
  s_waitcnt vmcnt(32)
  s_waitcnt vmcnt(4)
  buffer_load_dwordx4 v[96:99], v5, s[32:35], s36 offen offset:0 nt
  s_waitcnt lgkmcnt(0)
  v_max_f32_dpp v31, v30, v30 row_ror:8 row_mask:0xf bank_mask:0xf
  s_nop 1
  v_max_f32_dpp v31, v31, v31 row_half_mirror row_mask:0xf bank_mask:0xf
  s_nop 1
  v_max_f32_dpp v31, v31, v31 quad_perm:[2,3,0,1] row_mask:0xf bank_mask:0xf
  v_max_f32 v31, v31, v28
  v_sub_f32 v33, v28, v31
  v_sub_f32 v30, v30, v31
  v_mov_b32 v28, v31
  v_mul_f32 v33, s53, v33
  v_mul_f32 v30, s53, v30
  v_exp_f32 v33, v33
  v_exp_f32 v30, v30
  s_waitcnt vmcnt(4)
  buffer_load_dwordx4 v[100:103], v5, s[32:35], s36 offen offset:1024 nt
  v_mul_f32 v20, v20, v33
  v_mul_f32 v21, v21, v33
  v_mul_f32 v22, v22, v33
  v_mul_f32 v23, v23, v33
  v_mul_f32 v24, v24, v33
  v_mul_f32 v25, v25, v33
  v_mul_f32 v26, v26, v33
  v_mul_f32 v27, v27, v33
  v_fma_f32 v29, v29, v33, v30
  v_cvt_pk_bf16_f32 v34, v30, 0
  v_cvt_pk_bf16_f32 v35, 0, v30
  s_nop 0
  v_dot2c_f32_bf16_dpp v20, v34, v128 row_newbcast:0 row_mask:0xf bank_mask:0xf
  s_waitcnt vmcnt(4)
  buffer_load_dwordx4 v[104:107], v5, s[32:35], s36 offen offset:2048 nt
  v_dot2c_f32_bf16_dpp v21, v35, v128 row_newbcast:0 row_mask:0xf bank_mask:0xf
  v_dot2c_f32_bf16_dpp v22, v34, v129 row_newbcast:0 row_mask:0xf bank_mask:0xf
  v_dot2c_f32_bf16_dpp v23, v35, v129 row_newbcast:0 row_mask:0xf bank_mask:0xf
  v_dot2c_f32_bf16_dpp v24, v34, v130 row_newbcast:0 row_mask:0xf bank_mask:0xf
  v_dot2c_f32_bf16_dpp v25, v35, v130 row_newbcast:0 row_mask:0xf bank_mask:0xf
  v_dot2c_f32_bf16_dpp v26, v34, v131 row_newbcast:0 row_mask:0xf bank_mask:0xf
  v_dot2c_f32_bf16_dpp v27, v35, v131 row_newbcast:0 row_mask:0xf bank_mask:0xf
  v_dot2c_f32_bf16_dpp v20, v34, v132 row_newbcast:8 row_mask:0xf bank_mask:0xf
  v_dot2c_f32_bf16_dpp v21, v35, v132 row_newbcast:8 row_mask:0xf bank_mask:0xf
  v_dot2c_f32_bf16_dpp v22, v34, v133 row_newbcast:8 row_mask:0xf bank_mask:0xf
  v_dot2c_f32_bf16_dpp v23, v35, v133 row_newbcast:8 row_mask:0xf bank_mask:0xf
  v_dot2c_f32_bf16_dpp v24, v34, v134 row_newbcast:8 row_mask:0xf bank_mask:0xf
  s_waitcnt vmcnt(4)
  buffer_load_dwordx4 v[108:111], v5, s[32:35], s36 offen offset:3072 nt
  v_dot2c_f32_bf16_dpp v25, v35, v134 row_newbcast:8 row_mask:0xf bank_mask:0xf
  v_dot2c_f32_bf16_dpp v26, v34, v135 row_newbcast:8 row_mask:0xf bank_mask:0xf
  v_dot2c_f32_bf16_dpp v27, v35, v135 row_newbcast:8 row_mask:0xf bank_mask:0xf
  v_dot2c_f32_bf16_dpp v20, v34, v136 row_newbcast:4 row_mask:0xf bank_mask:0xf
  v_dot2c_f32_bf16_dpp v21, v35, v136 row_newbcast:4 row_mask:0xf bank_mask:0xf
  v_dot2c_f32_bf16_dpp v22, v34, v137 row_newbcast:4 row_mask:0xf bank_mask:0xf
  v_dot2c_f32_bf16_dpp v23, v35, v137 row_newbcast:4 row_mask:0xf bank_mask:0xf
  v_dot2c_f32_bf16_dpp v24, v34, v138 row_newbcast:4 row_mask:0xf bank_mask:0xf
  v_dot2c_f32_bf16_dpp v25, v35, v138 row_newbcast:4 row_mask:0xf bank_mask:0xf
  v_dot2c_f32_bf16_dpp v26, v34, v139 row_newbcast:4 row_mask:0xf bank_mask:0xf
  v_dot2c_f32_bf16_dpp v27, v35, v139 row_newbcast:4 row_mask:0xf bank_mask:0xf
  v_dot2c_f32_bf16_dpp v20, v34, v140 row_newbcast:12 row_mask:0xf bank_mask:0xf
  s_waitcnt vmcnt(4)
  buffer_load_dwordx4 v[112:115], v5, s[32:35], s37 offen offset:0 nt
  v_dot2c_f32_bf16_dpp v21, v35, v140 row_newbcast:12 row_mask:0xf bank_mask:0xf
  v_dot2c_f32_bf16_dpp v22, v34, v141 row_newbcast:12 row_mask:0xf bank_mask:0xf
  v_dot2c_f32_bf16_dpp v23, v35, v141 row_newbcast:12 row_mask:0xf bank_mask:0xf
  v_dot2c_f32_bf16_dpp v24, v34, v142 row_newbcast:12 row_mask:0xf bank_mask:0xf
  v_dot2c_f32_bf16_dpp v25, v35, v142 row_newbcast:12 row_mask:0xf bank_mask:0xf
  v_dot2c_f32_bf16_dpp v26, v34, v143 row_newbcast:12 row_mask:0xf bank_mask:0xf
  v_dot2c_f32_bf16_dpp v27, v35, v143 row_newbcast:12 row_mask:0xf bank_mask:0xf
  v_dot2c_f32_bf16_dpp v20, v34, v144 row_newbcast:2 row_mask:0xf bank_mask:0xf
  v_dot2c_f32_bf16_dpp v21, v35, v144 row_newbcast:2 row_mask:0xf bank_mask:0xf
  v_dot2c_f32_bf16_dpp v22, v34, v145 row_newbcast:2 row_mask:0xf bank_mask:0xf
  v_dot2c_f32_bf16_dpp v23, v35, v145 row_newbcast:2 row_mask:0xf bank_mask:0xf
  v_dot2c_f32_bf16_dpp v24, v34, v146 row_newbcast:2 row_mask:0xf bank_mask:0xf
  s_waitcnt vmcnt(4)
  buffer_load_dwordx4 v[116:119], v5, s[32:35], s37 offen offset:1024 nt
  v_dot2c_f32_bf16_dpp v25, v35, v146 row_newbcast:2 row_mask:0xf bank_mask:0xf
  v_dot2c_f32_bf16_dpp v26, v34, v147 row_newbcast:2 row_mask:0xf bank_mask:0xf
  v_dot2c_f32_bf16_dpp v27, v35, v147 row_newbcast:2 row_mask:0xf bank_mask:0xf
  v_dot2c_f32_bf16_dpp v20, v34, v148 row_newbcast:10 row_mask:0xf bank_mask:0xf
  v_dot2c_f32_bf16_dpp v21, v35, v148 row_newbcast:10 row_mask:0xf bank_mask:0xf
  v_dot2c_f32_bf16_dpp v22, v34, v149 row_newbcast:10 row_mask:0xf bank_mask:0xf
  v_dot2c_f32_bf16_dpp v23, v35, v149 row_newbcast:10 row_mask:0xf bank_mask:0xf
  v_dot2c_f32_bf16_dpp v24, v34, v150 row_newbcast:10 row_mask:0xf bank_mask:0xf
  v_dot2c_f32_bf16_dpp v25, v35, v150 row_newbcast:10 row_mask:0xf bank_mask:0xf
  v_dot2c_f32_bf16_dpp v26, v34, v151 row_newbcast:10 row_mask:0xf bank_mask:0xf
  v_dot2c_f32_bf16_dpp v27, v35, v151 row_newbcast:10 row_mask:0xf bank_mask:0xf
  v_dot2c_f32_bf16_dpp v20, v34, v152 row_newbcast:6 row_mask:0xf bank_mask:0xf
  s_waitcnt vmcnt(4)
  buffer_load_dwordx4 v[120:123], v5, s[32:35], s37 offen offset:2048 nt
  v_dot2c_f32_bf16_dpp v21, v35, v152 row_newbcast:6 row_mask:0xf bank_mask:0xf
  v_dot2c_f32_bf16_dpp v22, v34, v153 row_newbcast:6 row_mask:0xf bank_mask:0xf
  v_dot2c_f32_bf16_dpp v23, v35, v153 row_newbcast:6 row_mask:0xf bank_mask:0xf
  v_dot2c_f32_bf16_dpp v24, v34, v154 row_newbcast:6 row_mask:0xf bank_mask:0xf
  v_dot2c_f32_bf16_dpp v25, v35, v154 row_newbcast:6 row_mask:0xf bank_mask:0xf
  v_dot2c_f32_bf16_dpp v26, v34, v155 row_newbcast:6 row_mask:0xf bank_mask:0xf
  v_dot2c_f32_bf16_dpp v27, v35, v155 row_newbcast:6 row_mask:0xf bank_mask:0xf
  v_dot2c_f32_bf16_dpp v20, v34, v156 row_newbcast:14 row_mask:0xf bank_mask:0xf
  v_dot2c_f32_bf16_dpp v21, v35, v156 row_newbcast:14 row_mask:0xf bank_mask:0xf
  v_dot2c_f32_bf16_dpp v22, v34, v157 row_newbcast:14 row_mask:0xf bank_mask:0xf
  v_dot2c_f32_bf16_dpp v23, v35, v157 row_newbcast:14 row_mask:0xf bank_mask:0xf
  v_dot2c_f32_bf16_dpp v24, v34, v158 row_newbcast:14 row_mask:0xf bank_mask:0xf
  s_waitcnt vmcnt(4)
  buffer_load_dwordx4 v[124:127], v5, s[32:35], s37 offen offset:3072 nt
  v_dot2c_f32_bf16_dpp v25, v35, v158 row_newbcast:14 row_mask:0xf bank_mask:0xf
  v_dot2c_f32_bf16_dpp v26, v34, v159 row_newbcast:14 row_mask:0xf bank_mask:0xf
  v_dot2c_f32_bf16_dpp v27, v35, v159 row_newbcast:14 row_mask:0xf bank_mask:0xf
  s_add_u32 s36, s70, s38
  s_add_u32 s37, s36, 4096
  s_add_u32 s38, s38, 32768
  ds_read_b32 v30, v42
  v_add_u32 v42, 128, v42
  s_waitcnt vmcnt(32)
  s_waitcnt vmcnt(4)
  buffer_load_dwordx4 v[128:131], v5, s[32:35], s36 offen offset:0 nt
  s_waitcnt lgkmcnt(0)
  v_max_f32_dpp v31, v30, v30 row_ror:8 row_mask:0xf bank_mask:0xf
  s_nop 1
  v_max_f32_dpp v31, v31, v31 row_half_mirror row_mask:0xf bank_mask:0xf
  s_nop 1
  v_max_f32_dpp v31, v31, v31 quad_perm:[2,3,0,1] row_mask:0xf bank_mask:0xf
  v_max_f32 v31, v31, v28
  v_sub_f32 v33, v28, v31
  v_sub_f32 v30, v30, v31
  v_mov_b32 v28, v31
  v_mul_f32 v33, s53, v33
  v_mul_f32 v30, s53, v30
  v_exp_f32 v33, v33
  v_exp_f32 v30, v30
  s_waitcnt vmcnt(4)
  buffer_load_dwordx4 v[132:135], v5, s[32:35], s36 offen offset:1024 nt
  v_mul_f32 v20, v20, v33
  v_mul_f32 v21, v21, v33
  v_mul_f32 v22, v22, v33
  v_mul_f32 v23, v23, v33
  v_mul_f32 v24, v24, v33
  v_mul_f32 v25, v25, v33
  v_mul_f32 v26, v26, v33
  v_mul_f32 v27, v27, v33
  v_fma_f32 v29, v29, v33, v30
  v_cvt_pk_bf16_f32 v34, v30, 0
  v_cvt_pk_bf16_f32 v35, 0, v30
  s_nop 0
  v_dot2c_f32_bf16_dpp v20, v34, v160 row_newbcast:0 row_mask:0xf bank_mask:0xf
  s_waitcnt vmcnt(4)
  buffer_load_dwordx4 v[136:139], v5, s[32:35], s36 offen offset:2048 nt
  v_dot2c_f32_bf16_dpp v21, v35, v160 row_newbcast:0 row_mask:0xf bank_mask:0xf
  v_dot2c_f32_bf16_dpp v22, v34, v161 row_newbcast:0 row_mask:0xf bank_mask:0xf
  v_dot2c_f32_bf16_dpp v23, v35, v161 row_newbcast:0 row_mask:0xf bank_mask:0xf
  v_dot2c_f32_bf16_dpp v24, v34, v162 row_newbcast:0 row_mask:0xf bank_mask:0xf
  v_dot2c_f32_bf16_dpp v25, v35, v162 row_newbcast:0 row_mask:0xf bank_mask:0xf
  v_dot2c_f32_bf16_dpp v26, v34, v163 row_newbcast:0 row_mask:0xf bank_mask:0xf
  v_dot2c_f32_bf16_dpp v27, v35, v163 row_newbcast:0 row_mask:0xf bank_mask:0xf
  v_dot2c_f32_bf16_dpp v20, v34, v164 row_newbcast:8 row_mask:0xf bank_mask:0xf
  v_dot2c_f32_bf16_dpp v21, v35, v164 row_newbcast:8 row_mask:0xf bank_mask:0xf
  v_dot2c_f32_bf16_dpp v22, v34, v165 row_newbcast:8 row_mask:0xf bank_mask:0xf
  v_dot2c_f32_bf16_dpp v23, v35, v165 row_newbcast:8 row_mask:0xf bank_mask:0xf
  v_dot2c_f32_bf16_dpp v24, v34, v166 row_newbcast:8 row_mask:0xf bank_mask:0xf
  s_waitcnt vmcnt(4)
  buffer_load_dwordx4 v[140:143], v5, s[32:35], s36 offen offset:3072 nt
  v_dot2c_f32_bf16_dpp v25, v35, v166 row_newbcast:8 row_mask:0xf bank_mask:0xf
  v_dot2c_f32_bf16_dpp v26, v34, v167 row_newbcast:8 row_mask:0xf bank_mask:0xf
  v_dot2c_f32_bf16_dpp v27, v35, v167 row_newbcast:8 row_mask:0xf bank_mask:0xf
  v_dot2c_f32_bf16_dpp v20, v34, v168 row_newbcast:4 row_mask:0xf bank_mask:0xf
  v_dot2c_f32_bf16_dpp v21, v35, v168 row_newbcast:4 row_mask:0xf bank_mask:0xf
  v_dot2c_f32_bf16_dpp v22, v34, v169 row_newbcast:4 row_mask:0xf bank_mask:0xf
  v_dot2c_f32_bf16_dpp v23, v35, v169 row_newbcast:4 row_mask:0xf bank_mask:0xf
  v_dot2c_f32_bf16_dpp v24, v34, v170 row_newbcast:4 row_mask:0xf bank_mask:0xf
  v_dot2c_f32_bf16_dpp v25, v35, v170 row_newbcast:4 row_mask:0xf bank_mask:0xf
  v_dot2c_f32_bf16_dpp v26, v34, v171 row_newbcast:4 row_mask:0xf bank_mask:0xf
  v_dot2c_f32_bf16_dpp v27, v35, v171 row_newbcast:4 row_mask:0xf bank_mask:0xf
  v_dot2c_f32_bf16_dpp v20, v34, v172 row_newbcast:12 row_mask:0xf bank_mask:0xf
  s_waitcnt vmcnt(4)
  buffer_load_dwordx4 v[144:147], v5, s[32:35], s37 offen offset:0 nt
  v_dot2c_f32_bf16_dpp v21, v35, v172 row_newbcast:12 row_mask:0xf bank_mask:0xf
  v_dot2c_f32_bf16_dpp v22, v34, v173 row_newbcast:12 row_mask:0xf bank_mask:0xf
  v_dot2c_f32_bf16_dpp v23, v35, v173 row_newbcast:12 row_mask:0xf bank_mask:0xf
  v_dot2c_f32_bf16_dpp v24, v34, v174 row_newbcast:12 row_mask:0xf bank_mask:0xf
  v_dot2c_f32_bf16_dpp v25, v35, v174 row_newbcast:12 row_mask:0xf bank_mask:0xf
  v_dot2c_f32_bf16_dpp v26, v34, v175 row_newbcast:12 row_mask:0xf bank_mask:0xf
  v_dot2c_f32_bf16_dpp v27, v35, v175 row_newbcast:12 row_mask:0xf bank_mask:0xf
  v_dot2c_f32_bf16_dpp v20, v34, v176 row_newbcast:2 row_mask:0xf bank_mask:0xf
  v_dot2c_f32_bf16_dpp v21, v35, v176 row_newbcast:2 row_mask:0xf bank_mask:0xf
  v_dot2c_f32_bf16_dpp v22, v34, v177 row_newbcast:2 row_mask:0xf bank_mask:0xf
  v_dot2c_f32_bf16_dpp v23, v35, v177 row_newbcast:2 row_mask:0xf bank_mask:0xf
  v_dot2c_f32_bf16_dpp v24, v34, v178 row_newbcast:2 row_mask:0xf bank_mask:0xf
  s_waitcnt vmcnt(4)
  buffer_load_dwordx4 v[148:151], v5, s[32:35], s37 offen offset:1024 nt
  v_dot2c_f32_bf16_dpp v25, v35, v178 row_newbcast:2 row_mask:0xf bank_mask:0xf
  v_dot2c_f32_bf16_dpp v26, v34, v179 row_newbcast:2 row_mask:0xf bank_mask:0xf
  v_dot2c_f32_bf16_dpp v27, v35, v179 row_newbcast:2 row_mask:0xf bank_mask:0xf
  v_dot2c_f32_bf16_dpp v20, v34, v180 row_newbcast:10 row_mask:0xf bank_mask:0xf
  v_dot2c_f32_bf16_dpp v21, v35, v180 row_newbcast:10 row_mask:0xf bank_mask:0xf
  v_dot2c_f32_bf16_dpp v22, v34, v181 row_newbcast:10 row_mask:0xf bank_mask:0xf
  v_dot2c_f32_bf16_dpp v23, v35, v181 row_newbcast:10 row_mask:0xf bank_mask:0xf
  v_dot2c_f32_bf16_dpp v24, v34, v182 row_newbcast:10 row_mask:0xf bank_mask:0xf
  v_dot2c_f32_bf16_dpp v25, v35, v182 row_newbcast:10 row_mask:0xf bank_mask:0xf
  v_dot2c_f32_bf16_dpp v26, v34, v183 row_newbcast:10 row_mask:0xf bank_mask:0xf
  v_dot2c_f32_bf16_dpp v27, v35, v183 row_newbcast:10 row_mask:0xf bank_mask:0xf
  v_dot2c_f32_bf16_dpp v20, v34, v184 row_newbcast:6 row_mask:0xf bank_mask:0xf
  s_waitcnt vmcnt(4)
  buffer_load_dwordx4 v[152:155], v5, s[32:35], s37 offen offset:2048 nt
  v_dot2c_f32_bf16_dpp v21, v35, v184 row_newbcast:6 row_mask:0xf bank_mask:0xf
  v_dot2c_f32_bf16_dpp v22, v34, v185 row_newbcast:6 row_mask:0xf bank_mask:0xf
  v_dot2c_f32_bf16_dpp v23, v35, v185 row_newbcast:6 row_mask:0xf bank_mask:0xf
  v_dot2c_f32_bf16_dpp v24, v34, v186 row_newbcast:6 row_mask:0xf bank_mask:0xf
  v_dot2c_f32_bf16_dpp v25, v35, v186 row_newbcast:6 row_mask:0xf bank_mask:0xf
  v_dot2c_f32_bf16_dpp v26, v34, v187 row_newbcast:6 row_mask:0xf bank_mask:0xf
  v_dot2c_f32_bf16_dpp v27, v35, v187 row_newbcast:6 row_mask:0xf bank_mask:0xf
  v_dot2c_f32_bf16_dpp v20, v34, v188 row_newbcast:14 row_mask:0xf bank_mask:0xf
  v_dot2c_f32_bf16_dpp v21, v35, v188 row_newbcast:14 row_mask:0xf bank_mask:0xf
  v_dot2c_f32_bf16_dpp v22, v34, v189 row_newbcast:14 row_mask:0xf bank_mask:0xf
  v_dot2c_f32_bf16_dpp v23, v35, v189 row_newbcast:14 row_mask:0xf bank_mask:0xf
  v_dot2c_f32_bf16_dpp v24, v34, v190 row_newbcast:14 row_mask:0xf bank_mask:0xf
  s_waitcnt vmcnt(4)
  buffer_load_dwordx4 v[156:159], v5, s[32:35], s37 offen offset:3072 nt
  v_dot2c_f32_bf16_dpp v25, v35, v190 row_newbcast:14 row_mask:0xf bank_mask:0xf
  v_dot2c_f32_bf16_dpp v26, v34, v191 row_newbcast:14 row_mask:0xf bank_mask:0xf
  v_dot2c_f32_bf16_dpp v27, v35, v191 row_newbcast:14 row_mask:0xf bank_mask:0xf
  s_add_u32 s36, s71, s38
  s_add_u32 s37, s36, 4096
  s_add_u32 s38, s38, 32768
  ds_read_b32 v30, v42
  v_add_u32 v42, 128, v42
  s_waitcnt vmcnt(32)
  s_waitcnt vmcnt(4)
  buffer_load_dwordx4 v[160:163], v5, s[32:35], s36 offen offset:0 nt
  s_waitcnt lgkmcnt(0)
  v_max_f32_dpp v31, v30, v30 row_ror:8 row_mask:0xf bank_mask:0xf
  s_nop 1
  v_max_f32_dpp v31, v31, v31 row_half_mirror row_mask:0xf bank_mask:0xf
  s_nop 1
  v_max_f32_dpp v31, v31, v31 quad_perm:[2,3,0,1] row_mask:0xf bank_mask:0xf
  v_max_f32 v31, v31, v28
  v_sub_f32 v33, v28, v31
  v_sub_f32 v30, v30, v31
  v_mov_b32 v28, v31
  v_mul_f32 v33, s53, v33
  v_mul_f32 v30, s53, v30
  v_exp_f32 v33, v33
  v_exp_f32 v30, v30
  s_waitcnt vmcnt(4)
  buffer_load_dwordx4 v[164:167], v5, s[32:35], s36 offen offset:1024 nt
  v_mul_f32 v20, v20, v33
  v_mul_f32 v21, v21, v33
  v_mul_f32 v22, v22, v33
  v_mul_f32 v23, v23, v33
  v_mul_f32 v24, v24, v33
  v_mul_f32 v25, v25, v33
  v_mul_f32 v26, v26, v33
  v_mul_f32 v27, v27, v33
  v_fma_f32 v29, v29, v33, v30
  v_cvt_pk_bf16_f32 v34, v30, 0
  v_cvt_pk_bf16_f32 v35, 0, v30
  s_nop 0
  v_dot2c_f32_bf16_dpp v20, v34, v192 row_newbcast:0 row_mask:0xf bank_mask:0xf
  s_waitcnt vmcnt(4)
  buffer_load_dwordx4 v[168:171], v5, s[32:35], s36 offen offset:2048 nt
  v_dot2c_f32_bf16_dpp v21, v35, v192 row_newbcast:0 row_mask:0xf bank_mask:0xf
  v_dot2c_f32_bf16_dpp v22, v34, v193 row_newbcast:0 row_mask:0xf bank_mask:0xf
  v_dot2c_f32_bf16_dpp v23, v35, v193 row_newbcast:0 row_mask:0xf bank_mask:0xf
  v_dot2c_f32_bf16_dpp v24, v34, v194 row_newbcast:0 row_mask:0xf bank_mask:0xf
  v_dot2c_f32_bf16_dpp v25, v35, v194 row_newbcast:0 row_mask:0xf bank_mask:0xf
  v_dot2c_f32_bf16_dpp v26, v34, v195 row_newbcast:0 row_mask:0xf bank_mask:0xf
  v_dot2c_f32_bf16_dpp v27, v35, v195 row_newbcast:0 row_mask:0xf bank_mask:0xf
  v_dot2c_f32_bf16_dpp v20, v34, v196 row_newbcast:8 row_mask:0xf bank_mask:0xf
  v_dot2c_f32_bf16_dpp v21, v35, v196 row_newbcast:8 row_mask:0xf bank_mask:0xf
  v_dot2c_f32_bf16_dpp v22, v34, v197 row_newbcast:8 row_mask:0xf bank_mask:0xf
  v_dot2c_f32_bf16_dpp v23, v35, v197 row_newbcast:8 row_mask:0xf bank_mask:0xf
  v_dot2c_f32_bf16_dpp v24, v34, v198 row_newbcast:8 row_mask:0xf bank_mask:0xf
  s_waitcnt vmcnt(4)
  buffer_load_dwordx4 v[172:175], v5, s[32:35], s36 offen offset:3072 nt
  v_dot2c_f32_bf16_dpp v25, v35, v198 row_newbcast:8 row_mask:0xf bank_mask:0xf
  v_dot2c_f32_bf16_dpp v26, v34, v199 row_newbcast:8 row_mask:0xf bank_mask:0xf
  v_dot2c_f32_bf16_dpp v27, v35, v199 row_newbcast:8 row_mask:0xf bank_mask:0xf
  v_dot2c_f32_bf16_dpp v20, v34, v200 row_newbcast:4 row_mask:0xf bank_mask:0xf
  v_dot2c_f32_bf16_dpp v21, v35, v200 row_newbcast:4 row_mask:0xf bank_mask:0xf
  v_dot2c_f32_bf16_dpp v22, v34, v201 row_newbcast:4 row_mask:0xf bank_mask:0xf
  v_dot2c_f32_bf16_dpp v23, v35, v201 row_newbcast:4 row_mask:0xf bank_mask:0xf
  v_dot2c_f32_bf16_dpp v24, v34, v202 row_newbcast:4 row_mask:0xf bank_mask:0xf
  v_dot2c_f32_bf16_dpp v25, v35, v202 row_newbcast:4 row_mask:0xf bank_mask:0xf
  v_dot2c_f32_bf16_dpp v26, v34, v203 row_newbcast:4 row_mask:0xf bank_mask:0xf
  v_dot2c_f32_bf16_dpp v27, v35, v203 row_newbcast:4 row_mask:0xf bank_mask:0xf
  v_dot2c_f32_bf16_dpp v20, v34, v204 row_newbcast:12 row_mask:0xf bank_mask:0xf
  s_waitcnt vmcnt(4)
  buffer_load_dwordx4 v[176:179], v5, s[32:35], s37 offen offset:0 nt
  v_dot2c_f32_bf16_dpp v21, v35, v204 row_newbcast:12 row_mask:0xf bank_mask:0xf
  v_dot2c_f32_bf16_dpp v22, v34, v205 row_newbcast:12 row_mask:0xf bank_mask:0xf
  v_dot2c_f32_bf16_dpp v23, v35, v205 row_newbcast:12 row_mask:0xf bank_mask:0xf
  v_dot2c_f32_bf16_dpp v24, v34, v206 row_newbcast:12 row_mask:0xf bank_mask:0xf
  v_dot2c_f32_bf16_dpp v25, v35, v206 row_newbcast:12 row_mask:0xf bank_mask:0xf
  v_dot2c_f32_bf16_dpp v26, v34, v207 row_newbcast:12 row_mask:0xf bank_mask:0xf
  v_dot2c_f32_bf16_dpp v27, v35, v207 row_newbcast:12 row_mask:0xf bank_mask:0xf
  v_dot2c_f32_bf16_dpp v20, v34, v208 row_newbcast:2 row_mask:0xf bank_mask:0xf
  v_dot2c_f32_bf16_dpp v21, v35, v208 row_newbcast:2 row_mask:0xf bank_mask:0xf
  v_dot2c_f32_bf16_dpp v22, v34, v209 row_newbcast:2 row_mask:0xf bank_mask:0xf
  v_dot2c_f32_bf16_dpp v23, v35, v209 row_newbcast:2 row_mask:0xf bank_mask:0xf
  v_dot2c_f32_bf16_dpp v24, v34, v210 row_newbcast:2 row_mask:0xf bank_mask:0xf
  s_waitcnt vmcnt(4)
  buffer_load_dwordx4 v[180:183], v5, s[32:35], s37 offen offset:1024 nt
  v_dot2c_f32_bf16_dpp v25, v35, v210 row_newbcast:2 row_mask:0xf bank_mask:0xf
  v_dot2c_f32_bf16_dpp v26, v34, v211 row_newbcast:2 row_mask:0xf bank_mask:0xf
  v_dot2c_f32_bf16_dpp v27, v35, v211 row_newbcast:2 row_mask:0xf bank_mask:0xf
  v_dot2c_f32_bf16_dpp v20, v34, v212 row_newbcast:10 row_mask:0xf bank_mask:0xf
  v_dot2c_f32_bf16_dpp v21, v35, v212 row_newbcast:10 row_mask:0xf bank_mask:0xf
  v_dot2c_f32_bf16_dpp v22, v34, v213 row_newbcast:10 row_mask:0xf bank_mask:0xf
  v_dot2c_f32_bf16_dpp v23, v35, v213 row_newbcast:10 row_mask:0xf bank_mask:0xf
  v_dot2c_f32_bf16_dpp v24, v34, v214 row_newbcast:10 row_mask:0xf bank_mask:0xf
  v_dot2c_f32_bf16_dpp v25, v35, v214 row_newbcast:10 row_mask:0xf bank_mask:0xf
  v_dot2c_f32_bf16_dpp v26, v34, v215 row_newbcast:10 row_mask:0xf bank_mask:0xf
  v_dot2c_f32_bf16_dpp v27, v35, v215 row_newbcast:10 row_mask:0xf bank_mask:0xf
  v_dot2c_f32_bf16_dpp v20, v34, v216 row_newbcast:6 row_mask:0xf bank_mask:0xf
  s_waitcnt vmcnt(4)
  buffer_load_dwordx4 v[184:187], v5, s[32:35], s37 offen offset:2048 nt
  v_dot2c_f32_bf16_dpp v21, v35, v216 row_newbcast:6 row_mask:0xf bank_mask:0xf
  v_dot2c_f32_bf16_dpp v22, v34, v217 row_newbcast:6 row_mask:0xf bank_mask:0xf
  v_dot2c_f32_bf16_dpp v23, v35, v217 row_newbcast:6 row_mask:0xf bank_mask:0xf
  v_dot2c_f32_bf16_dpp v24, v34, v218 row_newbcast:6 row_mask:0xf bank_mask:0xf
  v_dot2c_f32_bf16_dpp v25, v35, v218 row_newbcast:6 row_mask:0xf bank_mask:0xf
  v_dot2c_f32_bf16_dpp v26, v34, v219 row_newbcast:6 row_mask:0xf bank_mask:0xf
  v_dot2c_f32_bf16_dpp v27, v35, v219 row_newbcast:6 row_mask:0xf bank_mask:0xf
  v_dot2c_f32_bf16_dpp v20, v34, v220 row_newbcast:14 row_mask:0xf bank_mask:0xf
  v_dot2c_f32_bf16_dpp v21, v35, v220 row_newbcast:14 row_mask:0xf bank_mask:0xf
  v_dot2c_f32_bf16_dpp v22, v34, v221 row_newbcast:14 row_mask:0xf bank_mask:0xf
  v_dot2c_f32_bf16_dpp v23, v35, v221 row_newbcast:14 row_mask:0xf bank_mask:0xf
  v_dot2c_f32_bf16_dpp v24, v34, v222 row_newbcast:14 row_mask:0xf bank_mask:0xf
  s_waitcnt vmcnt(4)
  buffer_load_dwordx4 v[188:191], v5, s[32:35], s37 offen offset:3072 nt
  v_dot2c_f32_bf16_dpp v25, v35, v222 row_newbcast:14 row_mask:0xf bank_mask:0xf
  v_dot2c_f32_bf16_dpp v26, v34, v223 row_newbcast:14 row_mask:0xf bank_mask:0xf
  v_dot2c_f32_bf16_dpp v27, v35, v223 row_newbcast:14 row_mask:0xf bank_mask:0xf
  s_add_u32 s36, s70, s38
  s_add_u32 s37, s36, 4096
  s_add_u32 s38, s38, 32768
  ds_read_b32 v30, v42
  v_add_u32 v42, 128, v42
  s_waitcnt vmcnt(32)
  s_waitcnt vmcnt(4)
  buffer_load_dwordx4 v[192:195], v5, s[32:35], s36 offen offset:0 nt
  s_waitcnt lgkmcnt(0)
  v_max_f32_dpp v31, v30, v30 row_ror:8 row_mask:0xf bank_mask:0xf
  s_nop 1
  v_max_f32_dpp v31, v31, v31 row_half_mirror row_mask:0xf bank_mask:0xf
  s_nop 1
  v_max_f32_dpp v31, v31, v31 quad_perm:[2,3,0,1] row_mask:0xf bank_mask:0xf
  v_max_f32 v31, v31, v28
  v_sub_f32 v33, v28, v31
  v_sub_f32 v30, v30, v31
  v_mov_b32 v28, v31
  v_mul_f32 v33, s53, v33
  v_mul_f32 v30, s53, v30
  v_exp_f32 v33, v33
  v_exp_f32 v30, v30
  s_waitcnt vmcnt(4)
  buffer_load_dwordx4 v[196:199], v5, s[32:35], s36 offen offset:1024 nt
  v_mul_f32 v20, v20, v33
  v_mul_f32 v21, v21, v33
  v_mul_f32 v22, v22, v33
  v_mul_f32 v23, v23, v33
  v_mul_f32 v24, v24, v33
  v_mul_f32 v25, v25, v33
  v_mul_f32 v26, v26, v33
  v_mul_f32 v27, v27, v33
  v_fma_f32 v29, v29, v33, v30
  v_cvt_pk_bf16_f32 v34, v30, 0
  v_cvt_pk_bf16_f32 v35, 0, v30
  s_nop 0
  v_dot2c_f32_bf16_dpp v20, v34, v224 row_newbcast:0 row_mask:0xf bank_mask:0xf
  s_waitcnt vmcnt(4)
  buffer_load_dwordx4 v[200:203], v5, s[32:35], s36 offen offset:2048 nt
  v_dot2c_f32_bf16_dpp v21, v35, v224 row_newbcast:0 row_mask:0xf bank_mask:0xf
  v_dot2c_f32_bf16_dpp v22, v34, v225 row_newbcast:0 row_mask:0xf bank_mask:0xf
  v_dot2c_f32_bf16_dpp v23, v35, v225 row_newbcast:0 row_mask:0xf bank_mask:0xf
  v_dot2c_f32_bf16_dpp v24, v34, v226 row_newbcast:0 row_mask:0xf bank_mask:0xf
  v_dot2c_f32_bf16_dpp v25, v35, v226 row_newbcast:0 row_mask:0xf bank_mask:0xf
  v_dot2c_f32_bf16_dpp v26, v34, v227 row_newbcast:0 row_mask:0xf bank_mask:0xf
  v_dot2c_f32_bf16_dpp v27, v35, v227 row_newbcast:0 row_mask:0xf bank_mask:0xf
  v_dot2c_f32_bf16_dpp v20, v34, v228 row_newbcast:8 row_mask:0xf bank_mask:0xf
  v_dot2c_f32_bf16_dpp v21, v35, v228 row_newbcast:8 row_mask:0xf bank_mask:0xf
  v_dot2c_f32_bf16_dpp v22, v34, v229 row_newbcast:8 row_mask:0xf bank_mask:0xf
  v_dot2c_f32_bf16_dpp v23, v35, v229 row_newbcast:8 row_mask:0xf bank_mask:0xf
  v_dot2c_f32_bf16_dpp v24, v34, v230 row_newbcast:8 row_mask:0xf bank_mask:0xf
  s_waitcnt vmcnt(4)
  buffer_load_dwordx4 v[204:207], v5, s[32:35], s36 offen offset:3072 nt
  v_dot2c_f32_bf16_dpp v25, v35, v230 row_newbcast:8 row_mask:0xf bank_mask:0xf
  v_dot2c_f32_bf16_dpp v26, v34, v231 row_newbcast:8 row_mask:0xf bank_mask:0xf
  v_dot2c_f32_bf16_dpp v27, v35, v231 row_newbcast:8 row_mask:0xf bank_mask:0xf
  v_dot2c_f32_bf16_dpp v20, v34, v232 row_newbcast:4 row_mask:0xf bank_mask:0xf
  v_dot2c_f32_bf16_dpp v21, v35, v232 row_newbcast:4 row_mask:0xf bank_mask:0xf
  v_dot2c_f32_bf16_dpp v22, v34, v233 row_newbcast:4 row_mask:0xf bank_mask:0xf
  v_dot2c_f32_bf16_dpp v23, v35, v233 row_newbcast:4 row_mask:0xf bank_mask:0xf
  v_dot2c_f32_bf16_dpp v24, v34, v234 row_newbcast:4 row_mask:0xf bank_mask:0xf
  v_dot2c_f32_bf16_dpp v25, v35, v234 row_newbcast:4 row_mask:0xf bank_mask:0xf
  v_dot2c_f32_bf16_dpp v26, v34, v235 row_newbcast:4 row_mask:0xf bank_mask:0xf
  v_dot2c_f32_bf16_dpp v27, v35, v235 row_newbcast:4 row_mask:0xf bank_mask:0xf
  v_dot2c_f32_bf16_dpp v20, v34, v236 row_newbcast:12 row_mask:0xf bank_mask:0xf
  s_waitcnt vmcnt(4)
  buffer_load_dwordx4 v[208:211], v5, s[32:35], s37 offen offset:0 nt
  v_dot2c_f32_bf16_dpp v21, v35, v236 row_newbcast:12 row_mask:0xf bank_mask:0xf
  v_dot2c_f32_bf16_dpp v22, v34, v237 row_newbcast:12 row_mask:0xf bank_mask:0xf
  v_dot2c_f32_bf16_dpp v23, v35, v237 row_newbcast:12 row_mask:0xf bank_mask:0xf
  v_dot2c_f32_bf16_dpp v24, v34, v238 row_newbcast:12 row_mask:0xf bank_mask:0xf
  v_dot2c_f32_bf16_dpp v25, v35, v238 row_newbcast:12 row_mask:0xf bank_mask:0xf
  v_dot2c_f32_bf16_dpp v26, v34, v239 row_newbcast:12 row_mask:0xf bank_mask:0xf
  v_dot2c_f32_bf16_dpp v27, v35, v239 row_newbcast:12 row_mask:0xf bank_mask:0xf
  v_dot2c_f32_bf16_dpp v20, v34, v240 row_newbcast:2 row_mask:0xf bank_mask:0xf
  v_dot2c_f32_bf16_dpp v21, v35, v240 row_newbcast:2 row_mask:0xf bank_mask:0xf
  v_dot2c_f32_bf16_dpp v22, v34, v241 row_newbcast:2 row_mask:0xf bank_mask:0xf
  v_dot2c_f32_bf16_dpp v23, v35, v241 row_newbcast:2 row_mask:0xf bank_mask:0xf
  v_dot2c_f32_bf16_dpp v24, v34, v242 row_newbcast:2 row_mask:0xf bank_mask:0xf
  s_waitcnt vmcnt(4)
  buffer_load_dwordx4 v[212:215], v5, s[32:35], s37 offen offset:1024 nt
  v_dot2c_f32_bf16_dpp v25, v35, v242 row_newbcast:2 row_mask:0xf bank_mask:0xf
  v_dot2c_f32_bf16_dpp v26, v34, v243 row_newbcast:2 row_mask:0xf bank_mask:0xf
  v_dot2c_f32_bf16_dpp v27, v35, v243 row_newbcast:2 row_mask:0xf bank_mask:0xf
  v_dot2c_f32_bf16_dpp v20, v34, v244 row_newbcast:10 row_mask:0xf bank_mask:0xf
  v_dot2c_f32_bf16_dpp v21, v35, v244 row_newbcast:10 row_mask:0xf bank_mask:0xf
  v_dot2c_f32_bf16_dpp v22, v34, v245 row_newbcast:10 row_mask:0xf bank_mask:0xf
  v_dot2c_f32_bf16_dpp v23, v35, v245 row_newbcast:10 row_mask:0xf bank_mask:0xf
  v_dot2c_f32_bf16_dpp v24, v34, v246 row_newbcast:10 row_mask:0xf bank_mask:0xf
  v_dot2c_f32_bf16_dpp v25, v35, v246 row_newbcast:10 row_mask:0xf bank_mask:0xf
  v_dot2c_f32_bf16_dpp v26, v34, v247 row_newbcast:10 row_mask:0xf bank_mask:0xf
  v_dot2c_f32_bf16_dpp v27, v35, v247 row_newbcast:10 row_mask:0xf bank_mask:0xf
  v_dot2c_f32_bf16_dpp v20, v34, v248 row_newbcast:6 row_mask:0xf bank_mask:0xf
  s_waitcnt vmcnt(4)
  buffer_load_dwordx4 v[216:219], v5, s[32:35], s37 offen offset:2048 nt
  v_dot2c_f32_bf16_dpp v21, v35, v248 row_newbcast:6 row_mask:0xf bank_mask:0xf
  v_dot2c_f32_bf16_dpp v22, v34, v249 row_newbcast:6 row_mask:0xf bank_mask:0xf
  v_dot2c_f32_bf16_dpp v23, v35, v249 row_newbcast:6 row_mask:0xf bank_mask:0xf
  v_dot2c_f32_bf16_dpp v24, v34, v250 row_newbcast:6 row_mask:0xf bank_mask:0xf
  v_dot2c_f32_bf16_dpp v25, v35, v250 row_newbcast:6 row_mask:0xf bank_mask:0xf
  v_dot2c_f32_bf16_dpp v26, v34, v251 row_newbcast:6 row_mask:0xf bank_mask:0xf
  v_dot2c_f32_bf16_dpp v27, v35, v251 row_newbcast:6 row_mask:0xf bank_mask:0xf
  v_dot2c_f32_bf16_dpp v20, v34, v252 row_newbcast:14 row_mask:0xf bank_mask:0xf
  v_dot2c_f32_bf16_dpp v21, v35, v252 row_newbcast:14 row_mask:0xf bank_mask:0xf
  v_dot2c_f32_bf16_dpp v22, v34, v253 row_newbcast:14 row_mask:0xf bank_mask:0xf
  v_dot2c_f32_bf16_dpp v23, v35, v253 row_newbcast:14 row_mask:0xf bank_mask:0xf
  v_dot2c_f32_bf16_dpp v24, v34, v254 row_newbcast:14 row_mask:0xf bank_mask:0xf
  s_waitcnt vmcnt(4)
  buffer_load_dwordx4 v[220:223], v5, s[32:35], s37 offen offset:3072 nt
  v_dot2c_f32_bf16_dpp v25, v35, v254 row_newbcast:14 row_mask:0xf bank_mask:0xf
  v_dot2c_f32_bf16_dpp v26, v34, v255 row_newbcast:14 row_mask:0xf bank_mask:0xf
  v_dot2c_f32_bf16_dpp v27, v35, v255 row_newbcast:14 row_mask:0xf bank_mask:0xf
  s_add_u32 s36, s71, s38
  s_add_u32 s37, s36, 4096
  s_add_u32 s38, s38, 32768
  ds_read_b32 v30, v42
  v_add_u32 v42, 128, v42
  s_waitcnt vmcnt(32)
  s_waitcnt vmcnt(4)
  buffer_load_dwordx4 v[224:227], v5, s[32:35], s36 offen offset:0 nt
  s_waitcnt lgkmcnt(0)
  v_max_f32_dpp v31, v30, v30 row_ror:8 row_mask:0xf bank_mask:0xf
  s_nop 1
  v_max_f32_dpp v31, v31, v31 row_half_mirror row_mask:0xf bank_mask:0xf
  s_nop 1
  v_max_f32_dpp v31, v31, v31 quad_perm:[2,3,0,1] row_mask:0xf bank_mask:0xf
  v_max_f32 v31, v31, v28
  v_sub_f32 v33, v28, v31
  v_sub_f32 v30, v30, v31
  v_mov_b32 v28, v31
  v_mul_f32 v33, s53, v33
  v_mul_f32 v30, s53, v30
  v_exp_f32 v33, v33
  v_exp_f32 v30, v30
  s_waitcnt vmcnt(4)
  buffer_load_dwordx4 v[228:231], v5, s[32:35], s36 offen offset:1024 nt
  v_mul_f32 v20, v20, v33
  v_mul_f32 v21, v21, v33
  v_mul_f32 v22, v22, v33
  v_mul_f32 v23, v23, v33
  v_mul_f32 v24, v24, v33
  v_mul_f32 v25, v25, v33
  v_mul_f32 v26, v26, v33
  v_mul_f32 v27, v27, v33
  v_fma_f32 v29, v29, v33, v30
  v_cvt_pk_bf16_f32 v34, v30, 0
  v_cvt_pk_bf16_f32 v35, 0, v30
  s_nop 0
  v_dot2c_f32_bf16_dpp v20, v34, v64 row_newbcast:0 row_mask:0xf bank_mask:0xf
  s_waitcnt vmcnt(4)
  buffer_load_dwordx4 v[232:235], v5, s[32:35], s36 offen offset:2048 nt
  v_dot2c_f32_bf16_dpp v21, v35, v64 row_newbcast:0 row_mask:0xf bank_mask:0xf
  v_dot2c_f32_bf16_dpp v22, v34, v65 row_newbcast:0 row_mask:0xf bank_mask:0xf
  v_dot2c_f32_bf16_dpp v23, v35, v65 row_newbcast:0 row_mask:0xf bank_mask:0xf
  v_dot2c_f32_bf16_dpp v24, v34, v66 row_newbcast:0 row_mask:0xf bank_mask:0xf
  v_dot2c_f32_bf16_dpp v25, v35, v66 row_newbcast:0 row_mask:0xf bank_mask:0xf
  v_dot2c_f32_bf16_dpp v26, v34, v67 row_newbcast:0 row_mask:0xf bank_mask:0xf
  v_dot2c_f32_bf16_dpp v27, v35, v67 row_newbcast:0 row_mask:0xf bank_mask:0xf
  v_dot2c_f32_bf16_dpp v20, v34, v68 row_newbcast:8 row_mask:0xf bank_mask:0xf
  v_dot2c_f32_bf16_dpp v21, v35, v68 row_newbcast:8 row_mask:0xf bank_mask:0xf
  v_dot2c_f32_bf16_dpp v22, v34, v69 row_newbcast:8 row_mask:0xf bank_mask:0xf
  v_dot2c_f32_bf16_dpp v23, v35, v69 row_newbcast:8 row_mask:0xf bank_mask:0xf
  v_dot2c_f32_bf16_dpp v24, v34, v70 row_newbcast:8 row_mask:0xf bank_mask:0xf
  s_waitcnt vmcnt(4)
  buffer_load_dwordx4 v[236:239], v5, s[32:35], s36 offen offset:3072 nt
  v_dot2c_f32_bf16_dpp v25, v35, v70 row_newbcast:8 row_mask:0xf bank_mask:0xf
  v_dot2c_f32_bf16_dpp v26, v34, v71 row_newbcast:8 row_mask:0xf bank_mask:0xf
  v_dot2c_f32_bf16_dpp v27, v35, v71 row_newbcast:8 row_mask:0xf bank_mask:0xf
  v_dot2c_f32_bf16_dpp v20, v34, v72 row_newbcast:4 row_mask:0xf bank_mask:0xf
  v_dot2c_f32_bf16_dpp v21, v35, v72 row_newbcast:4 row_mask:0xf bank_mask:0xf
  v_dot2c_f32_bf16_dpp v22, v34, v73 row_newbcast:4 row_mask:0xf bank_mask:0xf
  v_dot2c_f32_bf16_dpp v23, v35, v73 row_newbcast:4 row_mask:0xf bank_mask:0xf
  v_dot2c_f32_bf16_dpp v24, v34, v74 row_newbcast:4 row_mask:0xf bank_mask:0xf
  v_dot2c_f32_bf16_dpp v25, v35, v74 row_newbcast:4 row_mask:0xf bank_mask:0xf
  v_dot2c_f32_bf16_dpp v26, v34, v75 row_newbcast:4 row_mask:0xf bank_mask:0xf
  v_dot2c_f32_bf16_dpp v27, v35, v75 row_newbcast:4 row_mask:0xf bank_mask:0xf
  v_dot2c_f32_bf16_dpp v20, v34, v76 row_newbcast:12 row_mask:0xf bank_mask:0xf
  s_waitcnt vmcnt(4)
  buffer_load_dwordx4 v[240:243], v5, s[32:35], s37 offen offset:0 nt
  v_dot2c_f32_bf16_dpp v21, v35, v76 row_newbcast:12 row_mask:0xf bank_mask:0xf
  v_dot2c_f32_bf16_dpp v22, v34, v77 row_newbcast:12 row_mask:0xf bank_mask:0xf
  v_dot2c_f32_bf16_dpp v23, v35, v77 row_newbcast:12 row_mask:0xf bank_mask:0xf
  v_dot2c_f32_bf16_dpp v24, v34, v78 row_newbcast:12 row_mask:0xf bank_mask:0xf
  v_dot2c_f32_bf16_dpp v25, v35, v78 row_newbcast:12 row_mask:0xf bank_mask:0xf
  v_dot2c_f32_bf16_dpp v26, v34, v79 row_newbcast:12 row_mask:0xf bank_mask:0xf
  v_dot2c_f32_bf16_dpp v27, v35, v79 row_newbcast:12 row_mask:0xf bank_mask:0xf
  v_dot2c_f32_bf16_dpp v20, v34, v80 row_newbcast:2 row_mask:0xf bank_mask:0xf
  v_dot2c_f32_bf16_dpp v21, v35, v80 row_newbcast:2 row_mask:0xf bank_mask:0xf
  v_dot2c_f32_bf16_dpp v22, v34, v81 row_newbcast:2 row_mask:0xf bank_mask:0xf
  v_dot2c_f32_bf16_dpp v23, v35, v81 row_newbcast:2 row_mask:0xf bank_mask:0xf
  v_dot2c_f32_bf16_dpp v24, v34, v82 row_newbcast:2 row_mask:0xf bank_mask:0xf
  s_waitcnt vmcnt(4)
  buffer_load_dwordx4 v[244:247], v5, s[32:35], s37 offen offset:1024 nt
  v_dot2c_f32_bf16_dpp v25, v35, v82 row_newbcast:2 row_mask:0xf bank_mask:0xf
  v_dot2c_f32_bf16_dpp v26, v34, v83 row_newbcast:2 row_mask:0xf bank_mask:0xf
  v_dot2c_f32_bf16_dpp v27, v35, v83 row_newbcast:2 row_mask:0xf bank_mask:0xf
  v_dot2c_f32_bf16_dpp v20, v34, v84 row_newbcast:10 row_mask:0xf bank_mask:0xf
  v_dot2c_f32_bf16_dpp v21, v35, v84 row_newbcast:10 row_mask:0xf bank_mask:0xf
  v_dot2c_f32_bf16_dpp v22, v34, v85 row_newbcast:10 row_mask:0xf bank_mask:0xf
  v_dot2c_f32_bf16_dpp v23, v35, v85 row_newbcast:10 row_mask:0xf bank_mask:0xf
  v_dot2c_f32_bf16_dpp v24, v34, v86 row_newbcast:10 row_mask:0xf bank_mask:0xf
  v_dot2c_f32_bf16_dpp v25, v35, v86 row_newbcast:10 row_mask:0xf bank_mask:0xf
  v_dot2c_f32_bf16_dpp v26, v34, v87 row_newbcast:10 row_mask:0xf bank_mask:0xf
  v_dot2c_f32_bf16_dpp v27, v35, v87 row_newbcast:10 row_mask:0xf bank_mask:0xf
  v_dot2c_f32_bf16_dpp v20, v34, v88 row_newbcast:6 row_mask:0xf bank_mask:0xf
  s_waitcnt vmcnt(4)
  buffer_load_dwordx4 v[248:251], v5, s[32:35], s37 offen offset:2048 nt
  v_dot2c_f32_bf16_dpp v21, v35, v88 row_newbcast:6 row_mask:0xf bank_mask:0xf
  v_dot2c_f32_bf16_dpp v22, v34, v89 row_newbcast:6 row_mask:0xf bank_mask:0xf
  v_dot2c_f32_bf16_dpp v23, v35, v89 row_newbcast:6 row_mask:0xf bank_mask:0xf
  v_dot2c_f32_bf16_dpp v24, v34, v90 row_newbcast:6 row_mask:0xf bank_mask:0xf
  v_dot2c_f32_bf16_dpp v25, v35, v90 row_newbcast:6 row_mask:0xf bank_mask:0xf
  v_dot2c_f32_bf16_dpp v26, v34, v91 row_newbcast:6 row_mask:0xf bank_mask:0xf
  v_dot2c_f32_bf16_dpp v27, v35, v91 row_newbcast:6 row_mask:0xf bank_mask:0xf
  v_dot2c_f32_bf16_dpp v20, v34, v92 row_newbcast:14 row_mask:0xf bank_mask:0xf
  v_dot2c_f32_bf16_dpp v21, v35, v92 row_newbcast:14 row_mask:0xf bank_mask:0xf
  v_dot2c_f32_bf16_dpp v22, v34, v93 row_newbcast:14 row_mask:0xf bank_mask:0xf
  v_dot2c_f32_bf16_dpp v23, v35, v93 row_newbcast:14 row_mask:0xf bank_mask:0xf
  v_dot2c_f32_bf16_dpp v24, v34, v94 row_newbcast:14 row_mask:0xf bank_mask:0xf
  s_waitcnt vmcnt(4)
  buffer_load_dwordx4 v[252:255], v5, s[32:35], s37 offen offset:3072 nt
  v_dot2c_f32_bf16_dpp v25, v35, v94 row_newbcast:14 row_mask:0xf bank_mask:0xf
  v_dot2c_f32_bf16_dpp v26, v34, v95 row_newbcast:14 row_mask:0xf bank_mask:0xf
  v_dot2c_f32_bf16_dpp v27, v35, v95 row_newbcast:14 row_mask:0xf bank_mask:0xf
  s_add_u32 s36, s70, s38
  s_add_u32 s37, s36, 4096
  s_add_u32 s38, s38, 32768
  ds_read_b32 v30, v42
  v_add_u32 v42, 128, v42
  s_waitcnt vmcnt(32)
  s_waitcnt vmcnt(4)
  buffer_load_dwordx4 v[64:67], v5, s[32:35], s36 offen offset:0 nt
  s_waitcnt lgkmcnt(0)
  v_max_f32_dpp v31, v30, v30 row_ror:8 row_mask:0xf bank_mask:0xf
  s_nop 1
  v_max_f32_dpp v31, v31, v31 row_half_mirror row_mask:0xf bank_mask:0xf
  s_nop 1
  v_max_f32_dpp v31, v31, v31 quad_perm:[2,3,0,1] row_mask:0xf bank_mask:0xf
  v_max_f32 v31, v31, v28
  v_sub_f32 v33, v28, v31
  v_sub_f32 v30, v30, v31
  v_mov_b32 v28, v31
  v_mul_f32 v33, s53, v33
  v_mul_f32 v30, s53, v30
  v_exp_f32 v33, v33
  v_exp_f32 v30, v30
  s_waitcnt vmcnt(4)
  buffer_load_dwordx4 v[68:71], v5, s[32:35], s36 offen offset:1024 nt
  v_mul_f32 v20, v20, v33
  v_mul_f32 v21, v21, v33
  v_mul_f32 v22, v22, v33
  v_mul_f32 v23, v23, v33
  v_mul_f32 v24, v24, v33
  v_mul_f32 v25, v25, v33
  v_mul_f32 v26, v26, v33
  v_mul_f32 v27, v27, v33
  v_fma_f32 v29, v29, v33, v30
  v_cvt_pk_bf16_f32 v34, v30, 0
  v_cvt_pk_bf16_f32 v35, 0, v30
  s_nop 0
  v_dot2c_f32_bf16_dpp v20, v34, v96 row_newbcast:0 row_mask:0xf bank_mask:0xf
  s_waitcnt vmcnt(4)
  buffer_load_dwordx4 v[72:75], v5, s[32:35], s36 offen offset:2048 nt
  v_dot2c_f32_bf16_dpp v21, v35, v96 row_newbcast:0 row_mask:0xf bank_mask:0xf
  v_dot2c_f32_bf16_dpp v22, v34, v97 row_newbcast:0 row_mask:0xf bank_mask:0xf
  v_dot2c_f32_bf16_dpp v23, v35, v97 row_newbcast:0 row_mask:0xf bank_mask:0xf
  v_dot2c_f32_bf16_dpp v24, v34, v98 row_newbcast:0 row_mask:0xf bank_mask:0xf
  v_dot2c_f32_bf16_dpp v25, v35, v98 row_newbcast:0 row_mask:0xf bank_mask:0xf
  v_dot2c_f32_bf16_dpp v26, v34, v99 row_newbcast:0 row_mask:0xf bank_mask:0xf
  v_dot2c_f32_bf16_dpp v27, v35, v99 row_newbcast:0 row_mask:0xf bank_mask:0xf
  v_dot2c_f32_bf16_dpp v20, v34, v100 row_newbcast:8 row_mask:0xf bank_mask:0xf
  v_dot2c_f32_bf16_dpp v21, v35, v100 row_newbcast:8 row_mask:0xf bank_mask:0xf
  v_dot2c_f32_bf16_dpp v22, v34, v101 row_newbcast:8 row_mask:0xf bank_mask:0xf
  v_dot2c_f32_bf16_dpp v23, v35, v101 row_newbcast:8 row_mask:0xf bank_mask:0xf
  v_dot2c_f32_bf16_dpp v24, v34, v102 row_newbcast:8 row_mask:0xf bank_mask:0xf
  s_waitcnt vmcnt(4)
  buffer_load_dwordx4 v[76:79], v5, s[32:35], s36 offen offset:3072 nt
  v_dot2c_f32_bf16_dpp v25, v35, v102 row_newbcast:8 row_mask:0xf bank_mask:0xf
  v_dot2c_f32_bf16_dpp v26, v34, v103 row_newbcast:8 row_mask:0xf bank_mask:0xf
  v_dot2c_f32_bf16_dpp v27, v35, v103 row_newbcast:8 row_mask:0xf bank_mask:0xf
  v_dot2c_f32_bf16_dpp v20, v34, v104 row_newbcast:4 row_mask:0xf bank_mask:0xf
  v_dot2c_f32_bf16_dpp v21, v35, v104 row_newbcast:4 row_mask:0xf bank_mask:0xf
  v_dot2c_f32_bf16_dpp v22, v34, v105 row_newbcast:4 row_mask:0xf bank_mask:0xf
  v_dot2c_f32_bf16_dpp v23, v35, v105 row_newbcast:4 row_mask:0xf bank_mask:0xf
  v_dot2c_f32_bf16_dpp v24, v34, v106 row_newbcast:4 row_mask:0xf bank_mask:0xf
  v_dot2c_f32_bf16_dpp v25, v35, v106 row_newbcast:4 row_mask:0xf bank_mask:0xf
  v_dot2c_f32_bf16_dpp v26, v34, v107 row_newbcast:4 row_mask:0xf bank_mask:0xf
  v_dot2c_f32_bf16_dpp v27, v35, v107 row_newbcast:4 row_mask:0xf bank_mask:0xf
  v_dot2c_f32_bf16_dpp v20, v34, v108 row_newbcast:12 row_mask:0xf bank_mask:0xf
  s_waitcnt vmcnt(4)
  buffer_load_dwordx4 v[80:83], v5, s[32:35], s37 offen offset:0 nt
  v_dot2c_f32_bf16_dpp v21, v35, v108 row_newbcast:12 row_mask:0xf bank_mask:0xf
  v_dot2c_f32_bf16_dpp v22, v34, v109 row_newbcast:12 row_mask:0xf bank_mask:0xf
  v_dot2c_f32_bf16_dpp v23, v35, v109 row_newbcast:12 row_mask:0xf bank_mask:0xf
  v_dot2c_f32_bf16_dpp v24, v34, v110 row_newbcast:12 row_mask:0xf bank_mask:0xf
  v_dot2c_f32_bf16_dpp v25, v35, v110 row_newbcast:12 row_mask:0xf bank_mask:0xf
  v_dot2c_f32_bf16_dpp v26, v34, v111 row_newbcast:12 row_mask:0xf bank_mask:0xf
  v_dot2c_f32_bf16_dpp v27, v35, v111 row_newbcast:12 row_mask:0xf bank_mask:0xf
  v_dot2c_f32_bf16_dpp v20, v34, v112 row_newbcast:2 row_mask:0xf bank_mask:0xf
  v_dot2c_f32_bf16_dpp v21, v35, v112 row_newbcast:2 row_mask:0xf bank_mask:0xf
  v_dot2c_f32_bf16_dpp v22, v34, v113 row_newbcast:2 row_mask:0xf bank_mask:0xf
  v_dot2c_f32_bf16_dpp v23, v35, v113 row_newbcast:2 row_mask:0xf bank_mask:0xf
  v_dot2c_f32_bf16_dpp v24, v34, v114 row_newbcast:2 row_mask:0xf bank_mask:0xf
  s_waitcnt vmcnt(4)
  buffer_load_dwordx4 v[84:87], v5, s[32:35], s37 offen offset:1024 nt
  v_dot2c_f32_bf16_dpp v25, v35, v114 row_newbcast:2 row_mask:0xf bank_mask:0xf
  v_dot2c_f32_bf16_dpp v26, v34, v115 row_newbcast:2 row_mask:0xf bank_mask:0xf
  v_dot2c_f32_bf16_dpp v27, v35, v115 row_newbcast:2 row_mask:0xf bank_mask:0xf
  v_dot2c_f32_bf16_dpp v20, v34, v116 row_newbcast:10 row_mask:0xf bank_mask:0xf
  v_dot2c_f32_bf16_dpp v21, v35, v116 row_newbcast:10 row_mask:0xf bank_mask:0xf
  v_dot2c_f32_bf16_dpp v22, v34, v117 row_newbcast:10 row_mask:0xf bank_mask:0xf
  v_dot2c_f32_bf16_dpp v23, v35, v117 row_newbcast:10 row_mask:0xf bank_mask:0xf
  v_dot2c_f32_bf16_dpp v24, v34, v118 row_newbcast:10 row_mask:0xf bank_mask:0xf
  v_dot2c_f32_bf16_dpp v25, v35, v118 row_newbcast:10 row_mask:0xf bank_mask:0xf
  v_dot2c_f32_bf16_dpp v26, v34, v119 row_newbcast:10 row_mask:0xf bank_mask:0xf
  v_dot2c_f32_bf16_dpp v27, v35, v119 row_newbcast:10 row_mask:0xf bank_mask:0xf
  v_dot2c_f32_bf16_dpp v20, v34, v120 row_newbcast:6 row_mask:0xf bank_mask:0xf
  s_waitcnt vmcnt(4)
  buffer_load_dwordx4 v[88:91], v5, s[32:35], s37 offen offset:2048 nt
  v_dot2c_f32_bf16_dpp v21, v35, v120 row_newbcast:6 row_mask:0xf bank_mask:0xf
  v_dot2c_f32_bf16_dpp v22, v34, v121 row_newbcast:6 row_mask:0xf bank_mask:0xf
  v_dot2c_f32_bf16_dpp v23, v35, v121 row_newbcast:6 row_mask:0xf bank_mask:0xf
  v_dot2c_f32_bf16_dpp v24, v34, v122 row_newbcast:6 row_mask:0xf bank_mask:0xf
  v_dot2c_f32_bf16_dpp v25, v35, v122 row_newbcast:6 row_mask:0xf bank_mask:0xf
  v_dot2c_f32_bf16_dpp v26, v34, v123 row_newbcast:6 row_mask:0xf bank_mask:0xf
  v_dot2c_f32_bf16_dpp v27, v35, v123 row_newbcast:6 row_mask:0xf bank_mask:0xf
  v_dot2c_f32_bf16_dpp v20, v34, v124 row_newbcast:14 row_mask:0xf bank_mask:0xf
  v_dot2c_f32_bf16_dpp v21, v35, v124 row_newbcast:14 row_mask:0xf bank_mask:0xf
  v_dot2c_f32_bf16_dpp v22, v34, v125 row_newbcast:14 row_mask:0xf bank_mask:0xf
  v_dot2c_f32_bf16_dpp v23, v35, v125 row_newbcast:14 row_mask:0xf bank_mask:0xf
  v_dot2c_f32_bf16_dpp v24, v34, v126 row_newbcast:14 row_mask:0xf bank_mask:0xf
  s_waitcnt vmcnt(4)
  buffer_load_dwordx4 v[92:95], v5, s[32:35], s37 offen offset:3072 nt
  v_dot2c_f32_bf16_dpp v25, v35, v126 row_newbcast:14 row_mask:0xf bank_mask:0xf
  v_dot2c_f32_bf16_dpp v26, v34, v127 row_newbcast:14 row_mask:0xf bank_mask:0xf
  v_dot2c_f32_bf16_dpp v27, v35, v127 row_newbcast:14 row_mask:0xf bank_mask:0xf
  s_cmp_lt_u32 s38, 950272
  s_nop 3
  s_cbranch_scc1 A_vloop
  s_add_u32 s36, s71, 950272
  s_add_u32 s37, s36, 4096
  ds_read_b32 v30, v42
  v_add_u32 v42, 128, v42
  s_waitcnt vmcnt(32)
  s_waitcnt vmcnt(11)
  buffer_load_dwordx4 v[96:99], v5, s[32:35], s36 offen offset:0 nt
  s_waitcnt lgkmcnt(0)
  v_max_f32_dpp v31, v30, v30 row_ror:8 row_mask:0xf bank_mask:0xf
  s_nop 1
  v_max_f32_dpp v31, v31, v31 row_half_mirror row_mask:0xf bank_mask:0xf
  s_nop 1
  v_max_f32_dpp v31, v31, v31 quad_perm:[2,3,0,1] row_mask:0xf bank_mask:0xf
  v_max_f32 v31, v31, v28
  v_sub_f32 v33, v28, v31
  v_sub_f32 v30, v30, v31
  v_mov_b32 v28, v31
  v_mul_f32 v33, s53, v33
  v_mul_f32 v30, s53, v30
  v_exp_f32 v33, v33
  v_exp_f32 v30, v30
  s_waitcnt vmcnt(11)
  buffer_load_dwordx4 v[100:103], v5, s[32:35], s36 offen offset:1024 nt
  v_mul_f32 v20, v20, v33
  v_mul_f32 v21, v21, v33
  v_mul_f32 v22, v22, v33
  v_mul_f32 v23, v23, v33
  v_mul_f32 v24, v24, v33
  v_mul_f32 v25, v25, v33
  v_mul_f32 v26, v26, v33
  v_mul_f32 v27, v27, v33
  v_fma_f32 v29, v29, v33, v30
  v_cvt_pk_bf16_f32 v34, v30, 0
  v_cvt_pk_bf16_f32 v35, 0, v30
  s_nop 0
  v_dot2c_f32_bf16_dpp v20, v34, v128 row_newbcast:0 row_mask:0xf bank_mask:0xf
  s_waitcnt vmcnt(11)
  buffer_load_dwordx4 v[104:107], v5, s[32:35], s36 offen offset:2048 nt
  v_dot2c_f32_bf16_dpp v21, v35, v128 row_newbcast:0 row_mask:0xf bank_mask:0xf
  v_dot2c_f32_bf16_dpp v22, v34, v129 row_newbcast:0 row_mask:0xf bank_mask:0xf
  v_dot2c_f32_bf16_dpp v23, v35, v129 row_newbcast:0 row_mask:0xf bank_mask:0xf
  v_dot2c_f32_bf16_dpp v24, v34, v130 row_newbcast:0 row_mask:0xf bank_mask:0xf
  v_dot2c_f32_bf16_dpp v25, v35, v130 row_newbcast:0 row_mask:0xf bank_mask:0xf
  v_dot2c_f32_bf16_dpp v26, v34, v131 row_newbcast:0 row_mask:0xf bank_mask:0xf
  v_dot2c_f32_bf16_dpp v27, v35, v131 row_newbcast:0 row_mask:0xf bank_mask:0xf
  v_dot2c_f32_bf16_dpp v20, v34, v132 row_newbcast:8 row_mask:0xf bank_mask:0xf
  v_dot2c_f32_bf16_dpp v21, v35, v132 row_newbcast:8 row_mask:0xf bank_mask:0xf
  v_dot2c_f32_bf16_dpp v22, v34, v133 row_newbcast:8 row_mask:0xf bank_mask:0xf
  v_dot2c_f32_bf16_dpp v23, v35, v133 row_newbcast:8 row_mask:0xf bank_mask:0xf
  v_dot2c_f32_bf16_dpp v24, v34, v134 row_newbcast:8 row_mask:0xf bank_mask:0xf
  s_waitcnt vmcnt(11)
  buffer_load_dwordx4 v[108:111], v5, s[32:35], s36 offen offset:3072 nt
  v_dot2c_f32_bf16_dpp v25, v35, v134 row_newbcast:8 row_mask:0xf bank_mask:0xf
  v_dot2c_f32_bf16_dpp v26, v34, v135 row_newbcast:8 row_mask:0xf bank_mask:0xf
  v_dot2c_f32_bf16_dpp v27, v35, v135 row_newbcast:8 row_mask:0xf bank_mask:0xf
  v_dot2c_f32_bf16_dpp v20, v34, v136 row_newbcast:4 row_mask:0xf bank_mask:0xf
  v_dot2c_f32_bf16_dpp v21, v35, v136 row_newbcast:4 row_mask:0xf bank_mask:0xf
  v_dot2c_f32_bf16_dpp v22, v34, v137 row_newbcast:4 row_mask:0xf bank_mask:0xf
  v_dot2c_f32_bf16_dpp v23, v35, v137 row_newbcast:4 row_mask:0xf bank_mask:0xf
  v_dot2c_f32_bf16_dpp v24, v34, v138 row_newbcast:4 row_mask:0xf bank_mask:0xf
  v_dot2c_f32_bf16_dpp v25, v35, v138 row_newbcast:4 row_mask:0xf bank_mask:0xf
  v_dot2c_f32_bf16_dpp v26, v34, v139 row_newbcast:4 row_mask:0xf bank_mask:0xf
  v_dot2c_f32_bf16_dpp v27, v35, v139 row_newbcast:4 row_mask:0xf bank_mask:0xf
  v_dot2c_f32_bf16_dpp v20, v34, v140 row_newbcast:12 row_mask:0xf bank_mask:0xf
  s_waitcnt vmcnt(11)
  buffer_load_dwordx4 v[112:115], v5, s[32:35], s37 offen offset:0 nt
  v_dot2c_f32_bf16_dpp v21, v35, v140 row_newbcast:12 row_mask:0xf bank_mask:0xf
  v_dot2c_f32_bf16_dpp v22, v34, v141 row_newbcast:12 row_mask:0xf bank_mask:0xf
  v_dot2c_f32_bf16_dpp v23, v35, v141 row_newbcast:12 row_mask:0xf bank_mask:0xf
  v_dot2c_f32_bf16_dpp v24, v34, v142 row_newbcast:12 row_mask:0xf bank_mask:0xf
  v_dot2c_f32_bf16_dpp v25, v35, v142 row_newbcast:12 row_mask:0xf bank_mask:0xf
  v_dot2c_f32_bf16_dpp v26, v34, v143 row_newbcast:12 row_mask:0xf bank_mask:0xf
  v_dot2c_f32_bf16_dpp v27, v35, v143 row_newbcast:12 row_mask:0xf bank_mask:0xf
  v_dot2c_f32_bf16_dpp v20, v34, v144 row_newbcast:2 row_mask:0xf bank_mask:0xf
  v_dot2c_f32_bf16_dpp v21, v35, v144 row_newbcast:2 row_mask:0xf bank_mask:0xf
  v_dot2c_f32_bf16_dpp v22, v34, v145 row_newbcast:2 row_mask:0xf bank_mask:0xf
  v_dot2c_f32_bf16_dpp v23, v35, v145 row_newbcast:2 row_mask:0xf bank_mask:0xf
  v_dot2c_f32_bf16_dpp v24, v34, v146 row_newbcast:2 row_mask:0xf bank_mask:0xf
  s_waitcnt vmcnt(11)
  buffer_load_dwordx4 v[116:119], v5, s[32:35], s37 offen offset:1024 nt
  v_dot2c_f32_bf16_dpp v25, v35, v146 row_newbcast:2 row_mask:0xf bank_mask:0xf
  v_dot2c_f32_bf16_dpp v26, v34, v147 row_newbcast:2 row_mask:0xf bank_mask:0xf
  v_dot2c_f32_bf16_dpp v27, v35, v147 row_newbcast:2 row_mask:0xf bank_mask:0xf
  v_dot2c_f32_bf16_dpp v20, v34, v148 row_newbcast:10 row_mask:0xf bank_mask:0xf
  v_dot2c_f32_bf16_dpp v21, v35, v148 row_newbcast:10 row_mask:0xf bank_mask:0xf
  v_dot2c_f32_bf16_dpp v22, v34, v149 row_newbcast:10 row_mask:0xf bank_mask:0xf
  v_dot2c_f32_bf16_dpp v23, v35, v149 row_newbcast:10 row_mask:0xf bank_mask:0xf
  v_dot2c_f32_bf16_dpp v24, v34, v150 row_newbcast:10 row_mask:0xf bank_mask:0xf
  v_dot2c_f32_bf16_dpp v25, v35, v150 row_newbcast:10 row_mask:0xf bank_mask:0xf
  v_dot2c_f32_bf16_dpp v26, v34, v151 row_newbcast:10 row_mask:0xf bank_mask:0xf
  v_dot2c_f32_bf16_dpp v27, v35, v151 row_newbcast:10 row_mask:0xf bank_mask:0xf
  v_dot2c_f32_bf16_dpp v20, v34, v152 row_newbcast:6 row_mask:0xf bank_mask:0xf
  s_waitcnt vmcnt(11)
  buffer_load_dwordx4 v[120:123], v5, s[32:35], s37 offen offset:2048 nt
  v_dot2c_f32_bf16_dpp v21, v35, v152 row_newbcast:6 row_mask:0xf bank_mask:0xf
  v_dot2c_f32_bf16_dpp v22, v34, v153 row_newbcast:6 row_mask:0xf bank_mask:0xf
  v_dot2c_f32_bf16_dpp v23, v35, v153 row_newbcast:6 row_mask:0xf bank_mask:0xf
  v_dot2c_f32_bf16_dpp v24, v34, v154 row_newbcast:6 row_mask:0xf bank_mask:0xf
  v_dot2c_f32_bf16_dpp v25, v35, v154 row_newbcast:6 row_mask:0xf bank_mask:0xf
  v_dot2c_f32_bf16_dpp v26, v34, v155 row_newbcast:6 row_mask:0xf bank_mask:0xf
  v_dot2c_f32_bf16_dpp v27, v35, v155 row_newbcast:6 row_mask:0xf bank_mask:0xf
  v_dot2c_f32_bf16_dpp v20, v34, v156 row_newbcast:14 row_mask:0xf bank_mask:0xf
  v_dot2c_f32_bf16_dpp v21, v35, v156 row_newbcast:14 row_mask:0xf bank_mask:0xf
  v_dot2c_f32_bf16_dpp v22, v34, v157 row_newbcast:14 row_mask:0xf bank_mask:0xf
  v_dot2c_f32_bf16_dpp v23, v35, v157 row_newbcast:14 row_mask:0xf bank_mask:0xf
  v_dot2c_f32_bf16_dpp v24, v34, v158 row_newbcast:14 row_mask:0xf bank_mask:0xf
  s_waitcnt vmcnt(11)
  buffer_load_dwordx4 v[124:127], v5, s[32:35], s37 offen offset:3072 nt
  v_dot2c_f32_bf16_dpp v25, v35, v158 row_newbcast:14 row_mask:0xf bank_mask:0xf
  v_dot2c_f32_bf16_dpp v26, v34, v159 row_newbcast:14 row_mask:0xf bank_mask:0xf
  v_dot2c_f32_bf16_dpp v27, v35, v159 row_newbcast:14 row_mask:0xf bank_mask:0xf
  s_add_u32 s36, s70, 983040
  s_add_u32 s37, s36, 4096
  ds_read_b32 v30, v42
  v_add_u32 v42, 128, v42
  s_waitcnt vmcnt(32)
  s_waitcnt vmcnt(11)
  buffer_load_dwordx4 v[128:131], v5, s[32:35], s36 offen offset:0 nt
  s_waitcnt lgkmcnt(0)
  v_max_f32_dpp v31, v30, v30 row_ror:8 row_mask:0xf bank_mask:0xf
  s_nop 1
  v_max_f32_dpp v31, v31, v31 row_half_mirror row_mask:0xf bank_mask:0xf
  s_nop 1
  v_max_f32_dpp v31, v31, v31 quad_perm:[2,3,0,1] row_mask:0xf bank_mask:0xf
  v_max_f32 v31, v31, v28
  v_sub_f32 v33, v28, v31
  v_sub_f32 v30, v30, v31
  v_mov_b32 v28, v31
  v_mul_f32 v33, s53, v33
  v_mul_f32 v30, s53, v30
  v_exp_f32 v33, v33
  v_exp_f32 v30, v30
  s_waitcnt vmcnt(11)
  buffer_load_dwordx4 v[132:135], v5, s[32:35], s36 offen offset:1024 nt
  v_mul_f32 v20, v20, v33
  v_mul_f32 v21, v21, v33
  v_mul_f32 v22, v22, v33
  v_mul_f32 v23, v23, v33
  v_mul_f32 v24, v24, v33
  v_mul_f32 v25, v25, v33
  v_mul_f32 v26, v26, v33
  v_mul_f32 v27, v27, v33
  v_fma_f32 v29, v29, v33, v30
  v_cvt_pk_bf16_f32 v34, v30, 0
  v_cvt_pk_bf16_f32 v35, 0, v30
  s_nop 0
  v_dot2c_f32_bf16_dpp v20, v34, v160 row_newbcast:0 row_mask:0xf bank_mask:0xf
  s_waitcnt vmcnt(11)
  buffer_load_dwordx4 v[136:139], v5, s[32:35], s36 offen offset:2048 nt
  v_dot2c_f32_bf16_dpp v21, v35, v160 row_newbcast:0 row_mask:0xf bank_mask:0xf
  v_dot2c_f32_bf16_dpp v22, v34, v161 row_newbcast:0 row_mask:0xf bank_mask:0xf
  v_dot2c_f32_bf16_dpp v23, v35, v161 row_newbcast:0 row_mask:0xf bank_mask:0xf
  v_dot2c_f32_bf16_dpp v24, v34, v162 row_newbcast:0 row_mask:0xf bank_mask:0xf
  v_dot2c_f32_bf16_dpp v25, v35, v162 row_newbcast:0 row_mask:0xf bank_mask:0xf
  v_dot2c_f32_bf16_dpp v26, v34, v163 row_newbcast:0 row_mask:0xf bank_mask:0xf
  v_dot2c_f32_bf16_dpp v27, v35, v163 row_newbcast:0 row_mask:0xf bank_mask:0xf
  v_dot2c_f32_bf16_dpp v20, v34, v164 row_newbcast:8 row_mask:0xf bank_mask:0xf
  v_dot2c_f32_bf16_dpp v21, v35, v164 row_newbcast:8 row_mask:0xf bank_mask:0xf
  v_dot2c_f32_bf16_dpp v22, v34, v165 row_newbcast:8 row_mask:0xf bank_mask:0xf
  v_dot2c_f32_bf16_dpp v23, v35, v165 row_newbcast:8 row_mask:0xf bank_mask:0xf
  v_dot2c_f32_bf16_dpp v24, v34, v166 row_newbcast:8 row_mask:0xf bank_mask:0xf
  s_waitcnt vmcnt(11)
  buffer_load_dwordx4 v[140:143], v5, s[32:35], s36 offen offset:3072 nt
  v_dot2c_f32_bf16_dpp v25, v35, v166 row_newbcast:8 row_mask:0xf bank_mask:0xf
  v_dot2c_f32_bf16_dpp v26, v34, v167 row_newbcast:8 row_mask:0xf bank_mask:0xf
  v_dot2c_f32_bf16_dpp v27, v35, v167 row_newbcast:8 row_mask:0xf bank_mask:0xf
  v_dot2c_f32_bf16_dpp v20, v34, v168 row_newbcast:4 row_mask:0xf bank_mask:0xf
  v_dot2c_f32_bf16_dpp v21, v35, v168 row_newbcast:4 row_mask:0xf bank_mask:0xf
  v_dot2c_f32_bf16_dpp v22, v34, v169 row_newbcast:4 row_mask:0xf bank_mask:0xf
  v_dot2c_f32_bf16_dpp v23, v35, v169 row_newbcast:4 row_mask:0xf bank_mask:0xf
  v_dot2c_f32_bf16_dpp v24, v34, v170 row_newbcast:4 row_mask:0xf bank_mask:0xf
  v_dot2c_f32_bf16_dpp v25, v35, v170 row_newbcast:4 row_mask:0xf bank_mask:0xf
  v_dot2c_f32_bf16_dpp v26, v34, v171 row_newbcast:4 row_mask:0xf bank_mask:0xf
  v_dot2c_f32_bf16_dpp v27, v35, v171 row_newbcast:4 row_mask:0xf bank_mask:0xf
  v_dot2c_f32_bf16_dpp v20, v34, v172 row_newbcast:12 row_mask:0xf bank_mask:0xf
  s_waitcnt vmcnt(11)
  buffer_load_dwordx4 v[144:147], v5, s[32:35], s37 offen offset:0 nt
  v_dot2c_f32_bf16_dpp v21, v35, v172 row_newbcast:12 row_mask:0xf bank_mask:0xf
  v_dot2c_f32_bf16_dpp v22, v34, v173 row_newbcast:12 row_mask:0xf bank_mask:0xf
  v_dot2c_f32_bf16_dpp v23, v35, v173 row_newbcast:12 row_mask:0xf bank_mask:0xf
  v_dot2c_f32_bf16_dpp v24, v34, v174 row_newbcast:12 row_mask:0xf bank_mask:0xf
  v_dot2c_f32_bf16_dpp v25, v35, v174 row_newbcast:12 row_mask:0xf bank_mask:0xf
  v_dot2c_f32_bf16_dpp v26, v34, v175 row_newbcast:12 row_mask:0xf bank_mask:0xf
  v_dot2c_f32_bf16_dpp v27, v35, v175 row_newbcast:12 row_mask:0xf bank_mask:0xf
  v_dot2c_f32_bf16_dpp v20, v34, v176 row_newbcast:2 row_mask:0xf bank_mask:0xf
  v_dot2c_f32_bf16_dpp v21, v35, v176 row_newbcast:2 row_mask:0xf bank_mask:0xf
  v_dot2c_f32_bf16_dpp v22, v34, v177 row_newbcast:2 row_mask:0xf bank_mask:0xf
  v_dot2c_f32_bf16_dpp v23, v35, v177 row_newbcast:2 row_mask:0xf bank_mask:0xf
  v_dot2c_f32_bf16_dpp v24, v34, v178 row_newbcast:2 row_mask:0xf bank_mask:0xf
  s_waitcnt vmcnt(11)
  buffer_load_dwordx4 v[148:151], v5, s[32:35], s37 offen offset:1024 nt
  v_dot2c_f32_bf16_dpp v25, v35, v178 row_newbcast:2 row_mask:0xf bank_mask:0xf
  v_dot2c_f32_bf16_dpp v26, v34, v179 row_newbcast:2 row_mask:0xf bank_mask:0xf
  v_dot2c_f32_bf16_dpp v27, v35, v179 row_newbcast:2 row_mask:0xf bank_mask:0xf
  v_dot2c_f32_bf16_dpp v20, v34, v180 row_newbcast:10 row_mask:0xf bank_mask:0xf
  v_dot2c_f32_bf16_dpp v21, v35, v180 row_newbcast:10 row_mask:0xf bank_mask:0xf
  v_dot2c_f32_bf16_dpp v22, v34, v181 row_newbcast:10 row_mask:0xf bank_mask:0xf
  v_dot2c_f32_bf16_dpp v23, v35, v181 row_newbcast:10 row_mask:0xf bank_mask:0xf
  v_dot2c_f32_bf16_dpp v24, v34, v182 row_newbcast:10 row_mask:0xf bank_mask:0xf
  v_dot2c_f32_bf16_dpp v25, v35, v182 row_newbcast:10 row_mask:0xf bank_mask:0xf
  v_dot2c_f32_bf16_dpp v26, v34, v183 row_newbcast:10 row_mask:0xf bank_mask:0xf
  v_dot2c_f32_bf16_dpp v27, v35, v183 row_newbcast:10 row_mask:0xf bank_mask:0xf
  v_dot2c_f32_bf16_dpp v20, v34, v184 row_newbcast:6 row_mask:0xf bank_mask:0xf
  s_waitcnt vmcnt(11)
  buffer_load_dwordx4 v[152:155], v5, s[32:35], s37 offen offset:2048 nt
  v_dot2c_f32_bf16_dpp v21, v35, v184 row_newbcast:6 row_mask:0xf bank_mask:0xf
  v_dot2c_f32_bf16_dpp v22, v34, v185 row_newbcast:6 row_mask:0xf bank_mask:0xf
  v_dot2c_f32_bf16_dpp v23, v35, v185 row_newbcast:6 row_mask:0xf bank_mask:0xf
  v_dot2c_f32_bf16_dpp v24, v34, v186 row_newbcast:6 row_mask:0xf bank_mask:0xf
  v_dot2c_f32_bf16_dpp v25, v35, v186 row_newbcast:6 row_mask:0xf bank_mask:0xf
  v_dot2c_f32_bf16_dpp v26, v34, v187 row_newbcast:6 row_mask:0xf bank_mask:0xf
  v_dot2c_f32_bf16_dpp v27, v35, v187 row_newbcast:6 row_mask:0xf bank_mask:0xf
  v_dot2c_f32_bf16_dpp v20, v34, v188 row_newbcast:14 row_mask:0xf bank_mask:0xf
  v_dot2c_f32_bf16_dpp v21, v35, v188 row_newbcast:14 row_mask:0xf bank_mask:0xf
  v_dot2c_f32_bf16_dpp v22, v34, v189 row_newbcast:14 row_mask:0xf bank_mask:0xf
  v_dot2c_f32_bf16_dpp v23, v35, v189 row_newbcast:14 row_mask:0xf bank_mask:0xf
  v_dot2c_f32_bf16_dpp v24, v34, v190 row_newbcast:14 row_mask:0xf bank_mask:0xf
  s_waitcnt vmcnt(11)
  buffer_load_dwordx4 v[156:159], v5, s[32:35], s37 offen offset:3072 nt
  v_dot2c_f32_bf16_dpp v25, v35, v190 row_newbcast:14 row_mask:0xf bank_mask:0xf
  v_dot2c_f32_bf16_dpp v26, v34, v191 row_newbcast:14 row_mask:0xf bank_mask:0xf
  v_dot2c_f32_bf16_dpp v27, v35, v191 row_newbcast:14 row_mask:0xf bank_mask:0xf
  s_add_u32 s36, s71, 1015808
  s_add_u32 s37, s36, 4096
  ds_read_b32 v30, v42
  v_add_u32 v42, 128, v42
  s_waitcnt vmcnt(32)
  s_waitcnt vmcnt(11)
  buffer_load_dwordx4 v[160:163], v5, s[32:35], s36 offen offset:0 nt
  s_waitcnt lgkmcnt(0)
  v_max_f32_dpp v31, v30, v30 row_ror:8 row_mask:0xf bank_mask:0xf
  s_nop 1
  v_max_f32_dpp v31, v31, v31 row_half_mirror row_mask:0xf bank_mask:0xf
  s_nop 1
  v_max_f32_dpp v31, v31, v31 quad_perm:[2,3,0,1] row_mask:0xf bank_mask:0xf
  v_max_f32 v31, v31, v28
  v_sub_f32 v33, v28, v31
  v_sub_f32 v30, v30, v31
  v_mov_b32 v28, v31
  v_mul_f32 v33, s53, v33
  v_mul_f32 v30, s53, v30
  v_exp_f32 v33, v33
  v_exp_f32 v30, v30
  s_waitcnt vmcnt(11)
  buffer_load_dwordx4 v[164:167], v5, s[32:35], s36 offen offset:1024 nt
  v_mul_f32 v20, v20, v33
  v_mul_f32 v21, v21, v33
  v_mul_f32 v22, v22, v33
  v_mul_f32 v23, v23, v33
  v_mul_f32 v24, v24, v33
  v_mul_f32 v25, v25, v33
  v_mul_f32 v26, v26, v33
  v_mul_f32 v27, v27, v33
  v_fma_f32 v29, v29, v33, v30
  v_cvt_pk_bf16_f32 v34, v30, 0
  v_cvt_pk_bf16_f32 v35, 0, v30
  s_nop 0
  v_dot2c_f32_bf16_dpp v20, v34, v192 row_newbcast:0 row_mask:0xf bank_mask:0xf
  s_waitcnt vmcnt(11)
  buffer_load_dwordx4 v[168:171], v5, s[32:35], s36 offen offset:2048 nt
  v_dot2c_f32_bf16_dpp v21, v35, v192 row_newbcast:0 row_mask:0xf bank_mask:0xf
  v_dot2c_f32_bf16_dpp v22, v34, v193 row_newbcast:0 row_mask:0xf bank_mask:0xf
  v_dot2c_f32_bf16_dpp v23, v35, v193 row_newbcast:0 row_mask:0xf bank_mask:0xf
  v_dot2c_f32_bf16_dpp v24, v34, v194 row_newbcast:0 row_mask:0xf bank_mask:0xf
  v_dot2c_f32_bf16_dpp v25, v35, v194 row_newbcast:0 row_mask:0xf bank_mask:0xf
  v_dot2c_f32_bf16_dpp v26, v34, v195 row_newbcast:0 row_mask:0xf bank_mask:0xf
  v_dot2c_f32_bf16_dpp v27, v35, v195 row_newbcast:0 row_mask:0xf bank_mask:0xf
  v_dot2c_f32_bf16_dpp v20, v34, v196 row_newbcast:8 row_mask:0xf bank_mask:0xf
  v_dot2c_f32_bf16_dpp v21, v35, v196 row_newbcast:8 row_mask:0xf bank_mask:0xf
  v_dot2c_f32_bf16_dpp v22, v34, v197 row_newbcast:8 row_mask:0xf bank_mask:0xf
  v_dot2c_f32_bf16_dpp v23, v35, v197 row_newbcast:8 row_mask:0xf bank_mask:0xf
  v_dot2c_f32_bf16_dpp v24, v34, v198 row_newbcast:8 row_mask:0xf bank_mask:0xf
  s_waitcnt vmcnt(11)
  buffer_load_dwordx4 v[172:175], v5, s[32:35], s36 offen offset:3072 nt
  v_dot2c_f32_bf16_dpp v25, v35, v198 row_newbcast:8 row_mask:0xf bank_mask:0xf
  v_dot2c_f32_bf16_dpp v26, v34, v199 row_newbcast:8 row_mask:0xf bank_mask:0xf
  v_dot2c_f32_bf16_dpp v27, v35, v199 row_newbcast:8 row_mask:0xf bank_mask:0xf
  v_dot2c_f32_bf16_dpp v20, v34, v200 row_newbcast:4 row_mask:0xf bank_mask:0xf
  v_dot2c_f32_bf16_dpp v21, v35, v200 row_newbcast:4 row_mask:0xf bank_mask:0xf
  v_dot2c_f32_bf16_dpp v22, v34, v201 row_newbcast:4 row_mask:0xf bank_mask:0xf
  v_dot2c_f32_bf16_dpp v23, v35, v201 row_newbcast:4 row_mask:0xf bank_mask:0xf
  v_dot2c_f32_bf16_dpp v24, v34, v202 row_newbcast:4 row_mask:0xf bank_mask:0xf
  v_dot2c_f32_bf16_dpp v25, v35, v202 row_newbcast:4 row_mask:0xf bank_mask:0xf
  v_dot2c_f32_bf16_dpp v26, v34, v203 row_newbcast:4 row_mask:0xf bank_mask:0xf
  v_dot2c_f32_bf16_dpp v27, v35, v203 row_newbcast:4 row_mask:0xf bank_mask:0xf
  v_dot2c_f32_bf16_dpp v20, v34, v204 row_newbcast:12 row_mask:0xf bank_mask:0xf
  s_waitcnt vmcnt(11)
  buffer_load_dwordx4 v[176:179], v5, s[32:35], s37 offen offset:0 nt
  v_dot2c_f32_bf16_dpp v21, v35, v204 row_newbcast:12 row_mask:0xf bank_mask:0xf
  v_dot2c_f32_bf16_dpp v22, v34, v205 row_newbcast:12 row_mask:0xf bank_mask:0xf
  v_dot2c_f32_bf16_dpp v23, v35, v205 row_newbcast:12 row_mask:0xf bank_mask:0xf
  v_dot2c_f32_bf16_dpp v24, v34, v206 row_newbcast:12 row_mask:0xf bank_mask:0xf
  v_dot2c_f32_bf16_dpp v25, v35, v206 row_newbcast:12 row_mask:0xf bank_mask:0xf
  v_dot2c_f32_bf16_dpp v26, v34, v207 row_newbcast:12 row_mask:0xf bank_mask:0xf
  v_dot2c_f32_bf16_dpp v27, v35, v207 row_newbcast:12 row_mask:0xf bank_mask:0xf
  v_dot2c_f32_bf16_dpp v20, v34, v208 row_newbcast:2 row_mask:0xf bank_mask:0xf
  v_dot2c_f32_bf16_dpp v21, v35, v208 row_newbcast:2 row_mask:0xf bank_mask:0xf
  v_dot2c_f32_bf16_dpp v22, v34, v209 row_newbcast:2 row_mask:0xf bank_mask:0xf
  v_dot2c_f32_bf16_dpp v23, v35, v209 row_newbcast:2 row_mask:0xf bank_mask:0xf
  v_dot2c_f32_bf16_dpp v24, v34, v210 row_newbcast:2 row_mask:0xf bank_mask:0xf
  s_waitcnt vmcnt(11)
  buffer_load_dwordx4 v[180:183], v5, s[32:35], s37 offen offset:1024 nt
  v_dot2c_f32_bf16_dpp v25, v35, v210 row_newbcast:2 row_mask:0xf bank_mask:0xf
  v_dot2c_f32_bf16_dpp v26, v34, v211 row_newbcast:2 row_mask:0xf bank_mask:0xf
  v_dot2c_f32_bf16_dpp v27, v35, v211 row_newbcast:2 row_mask:0xf bank_mask:0xf
  v_dot2c_f32_bf16_dpp v20, v34, v212 row_newbcast:10 row_mask:0xf bank_mask:0xf
  v_dot2c_f32_bf16_dpp v21, v35, v212 row_newbcast:10 row_mask:0xf bank_mask:0xf
  v_dot2c_f32_bf16_dpp v22, v34, v213 row_newbcast:10 row_mask:0xf bank_mask:0xf
  v_dot2c_f32_bf16_dpp v23, v35, v213 row_newbcast:10 row_mask:0xf bank_mask:0xf
  v_dot2c_f32_bf16_dpp v24, v34, v214 row_newbcast:10 row_mask:0xf bank_mask:0xf
  v_dot2c_f32_bf16_dpp v25, v35, v214 row_newbcast:10 row_mask:0xf bank_mask:0xf
  v_dot2c_f32_bf16_dpp v26, v34, v215 row_newbcast:10 row_mask:0xf bank_mask:0xf
  v_dot2c_f32_bf16_dpp v27, v35, v215 row_newbcast:10 row_mask:0xf bank_mask:0xf
  v_dot2c_f32_bf16_dpp v20, v34, v216 row_newbcast:6 row_mask:0xf bank_mask:0xf
  s_waitcnt vmcnt(11)
  buffer_load_dwordx4 v[184:187], v5, s[32:35], s37 offen offset:2048 nt
  v_dot2c_f32_bf16_dpp v21, v35, v216 row_newbcast:6 row_mask:0xf bank_mask:0xf
  v_dot2c_f32_bf16_dpp v22, v34, v217 row_newbcast:6 row_mask:0xf bank_mask:0xf
  v_dot2c_f32_bf16_dpp v23, v35, v217 row_newbcast:6 row_mask:0xf bank_mask:0xf
  v_dot2c_f32_bf16_dpp v24, v34, v218 row_newbcast:6 row_mask:0xf bank_mask:0xf
  v_dot2c_f32_bf16_dpp v25, v35, v218 row_newbcast:6 row_mask:0xf bank_mask:0xf
  v_dot2c_f32_bf16_dpp v26, v34, v219 row_newbcast:6 row_mask:0xf bank_mask:0xf
  v_dot2c_f32_bf16_dpp v27, v35, v219 row_newbcast:6 row_mask:0xf bank_mask:0xf
  v_dot2c_f32_bf16_dpp v20, v34, v220 row_newbcast:14 row_mask:0xf bank_mask:0xf
  v_dot2c_f32_bf16_dpp v21, v35, v220 row_newbcast:14 row_mask:0xf bank_mask:0xf
  v_dot2c_f32_bf16_dpp v22, v34, v221 row_newbcast:14 row_mask:0xf bank_mask:0xf
  v_dot2c_f32_bf16_dpp v23, v35, v221 row_newbcast:14 row_mask:0xf bank_mask:0xf
  v_dot2c_f32_bf16_dpp v24, v34, v222 row_newbcast:14 row_mask:0xf bank_mask:0xf
  s_waitcnt vmcnt(11)
  buffer_load_dwordx4 v[188:191], v5, s[32:35], s37 offen offset:3072 nt
  v_dot2c_f32_bf16_dpp v25, v35, v222 row_newbcast:14 row_mask:0xf bank_mask:0xf
  v_dot2c_f32_bf16_dpp v26, v34, v223 row_newbcast:14 row_mask:0xf bank_mask:0xf
  v_dot2c_f32_bf16_dpp v27, v35, v223 row_newbcast:14 row_mask:0xf bank_mask:0xf
  v_mov_b32 v40, 30
  ds_write_b32 v60, v40 offset:32
  ds_read_b32 v30, v42
  v_add_u32 v42, 128, v42
  s_waitcnt lgkmcnt(0)
  v_max_f32_dpp v31, v30, v30 row_ror:8 row_mask:0xf bank_mask:0xf
  s_nop 1
  v_max_f32_dpp v31, v31, v31 row_half_mirror row_mask:0xf bank_mask:0xf
  s_nop 1
  v_max_f32_dpp v31, v31, v31 quad_perm:[2,3,0,1] row_mask:0xf bank_mask:0xf
  v_max_f32 v31, v31, v28
  v_sub_f32 v33, v28, v31
  v_sub_f32 v30, v30, v31
  v_mov_b32 v28, v31
  v_mul_f32 v33, s53, v33
  v_mul_f32 v30, s53, v30
  v_exp_f32 v33, v33
  v_exp_f32 v30, v30
  v_mul_f32 v20, v20, v33
  v_mul_f32 v21, v21, v33
  v_mul_f32 v22, v22, v33
  v_mul_f32 v23, v23, v33
  v_mul_f32 v24, v24, v33
  v_mul_f32 v25, v25, v33
  v_mul_f32 v26, v26, v33
  v_mul_f32 v27, v27, v33
  v_fma_f32 v29, v29, v33, v30
  v_cvt_pk_bf16_f32 v34, v30, 0
  v_cvt_pk_bf16_f32 v35, 0, v30
  s_waitcnt vmcnt(39)
  v_dot2c_f32_bf16_dpp v20, v34, v224 row_newbcast:0 row_mask:0xf bank_mask:0xf
  v_dot2c_f32_bf16_dpp v21, v35, v224 row_newbcast:0 row_mask:0xf bank_mask:0xf
  v_dot2c_f32_bf16_dpp v22, v34, v225 row_newbcast:0 row_mask:0xf bank_mask:0xf
  v_dot2c_f32_bf16_dpp v23, v35, v225 row_newbcast:0 row_mask:0xf bank_mask:0xf
  v_dot2c_f32_bf16_dpp v24, v34, v226 row_newbcast:0 row_mask:0xf bank_mask:0xf
  v_dot2c_f32_bf16_dpp v25, v35, v226 row_newbcast:0 row_mask:0xf bank_mask:0xf
  v_dot2c_f32_bf16_dpp v26, v34, v227 row_newbcast:0 row_mask:0xf bank_mask:0xf
  v_dot2c_f32_bf16_dpp v27, v35, v227 row_newbcast:0 row_mask:0xf bank_mask:0xf
  s_waitcnt vmcnt(38)
  v_dot2c_f32_bf16_dpp v20, v34, v228 row_newbcast:8 row_mask:0xf bank_mask:0xf
  v_dot2c_f32_bf16_dpp v21, v35, v228 row_newbcast:8 row_mask:0xf bank_mask:0xf
  v_dot2c_f32_bf16_dpp v22, v34, v229 row_newbcast:8 row_mask:0xf bank_mask:0xf
  v_dot2c_f32_bf16_dpp v23, v35, v229 row_newbcast:8 row_mask:0xf bank_mask:0xf
  v_dot2c_f32_bf16_dpp v24, v34, v230 row_newbcast:8 row_mask:0xf bank_mask:0xf
  v_dot2c_f32_bf16_dpp v25, v35, v230 row_newbcast:8 row_mask:0xf bank_mask:0xf
  v_dot2c_f32_bf16_dpp v26, v34, v231 row_newbcast:8 row_mask:0xf bank_mask:0xf
  v_dot2c_f32_bf16_dpp v27, v35, v231 row_newbcast:8 row_mask:0xf bank_mask:0xf
  s_waitcnt vmcnt(37)
  v_dot2c_f32_bf16_dpp v20, v34, v232 row_newbcast:4 row_mask:0xf bank_mask:0xf
  v_dot2c_f32_bf16_dpp v21, v35, v232 row_newbcast:4 row_mask:0xf bank_mask:0xf
  v_dot2c_f32_bf16_dpp v22, v34, v233 row_newbcast:4 row_mask:0xf bank_mask:0xf
  v_dot2c_f32_bf16_dpp v23, v35, v233 row_newbcast:4 row_mask:0xf bank_mask:0xf
  v_dot2c_f32_bf16_dpp v24, v34, v234 row_newbcast:4 row_mask:0xf bank_mask:0xf
  v_dot2c_f32_bf16_dpp v25, v35, v234 row_newbcast:4 row_mask:0xf bank_mask:0xf
  v_dot2c_f32_bf16_dpp v26, v34, v235 row_newbcast:4 row_mask:0xf bank_mask:0xf
  v_dot2c_f32_bf16_dpp v27, v35, v235 row_newbcast:4 row_mask:0xf bank_mask:0xf
  s_waitcnt vmcnt(36)
  v_dot2c_f32_bf16_dpp v20, v34, v236 row_newbcast:12 row_mask:0xf bank_mask:0xf
  v_dot2c_f32_bf16_dpp v21, v35, v236 row_newbcast:12 row_mask:0xf bank_mask:0xf
  v_dot2c_f32_bf16_dpp v22, v34, v237 row_newbcast:12 row_mask:0xf bank_mask:0xf
  v_dot2c_f32_bf16_dpp v23, v35, v237 row_newbcast:12 row_mask:0xf bank_mask:0xf
  v_dot2c_f32_bf16_dpp v24, v34, v238 row_newbcast:12 row_mask:0xf bank_mask:0xf
  v_dot2c_f32_bf16_dpp v25, v35, v238 row_newbcast:12 row_mask:0xf bank_mask:0xf
  v_dot2c_f32_bf16_dpp v26, v34, v239 row_newbcast:12 row_mask:0xf bank_mask:0xf
  v_dot2c_f32_bf16_dpp v27, v35, v239 row_newbcast:12 row_mask:0xf bank_mask:0xf
  s_waitcnt vmcnt(35)
  v_dot2c_f32_bf16_dpp v20, v34, v240 row_newbcast:2 row_mask:0xf bank_mask:0xf
  v_dot2c_f32_bf16_dpp v21, v35, v240 row_newbcast:2 row_mask:0xf bank_mask:0xf
  v_dot2c_f32_bf16_dpp v22, v34, v241 row_newbcast:2 row_mask:0xf bank_mask:0xf
  v_dot2c_f32_bf16_dpp v23, v35, v241 row_newbcast:2 row_mask:0xf bank_mask:0xf
  v_dot2c_f32_bf16_dpp v24, v34, v242 row_newbcast:2 row_mask:0xf bank_mask:0xf
  v_dot2c_f32_bf16_dpp v25, v35, v242 row_newbcast:2 row_mask:0xf bank_mask:0xf
  v_dot2c_f32_bf16_dpp v26, v34, v243 row_newbcast:2 row_mask:0xf bank_mask:0xf
  v_dot2c_f32_bf16_dpp v27, v35, v243 row_newbcast:2 row_mask:0xf bank_mask:0xf
  s_waitcnt vmcnt(34)
  v_dot2c_f32_bf16_dpp v20, v34, v244 row_newbcast:10 row_mask:0xf bank_mask:0xf
  v_dot2c_f32_bf16_dpp v21, v35, v244 row_newbcast:10 row_mask:0xf bank_mask:0xf
  v_dot2c_f32_bf16_dpp v22, v34, v245 row_newbcast:10 row_mask:0xf bank_mask:0xf
  v_dot2c_f32_bf16_dpp v23, v35, v245 row_newbcast:10 row_mask:0xf bank_mask:0xf
  v_dot2c_f32_bf16_dpp v24, v34, v246 row_newbcast:10 row_mask:0xf bank_mask:0xf
  v_dot2c_f32_bf16_dpp v25, v35, v246 row_newbcast:10 row_mask:0xf bank_mask:0xf
  v_dot2c_f32_bf16_dpp v26, v34, v247 row_newbcast:10 row_mask:0xf bank_mask:0xf
  v_dot2c_f32_bf16_dpp v27, v35, v247 row_newbcast:10 row_mask:0xf bank_mask:0xf
  s_waitcnt vmcnt(33)
  v_dot2c_f32_bf16_dpp v20, v34, v248 row_newbcast:6 row_mask:0xf bank_mask:0xf
  v_dot2c_f32_bf16_dpp v21, v35, v248 row_newbcast:6 row_mask:0xf bank_mask:0xf
  v_dot2c_f32_bf16_dpp v22, v34, v249 row_newbcast:6 row_mask:0xf bank_mask:0xf
  v_dot2c_f32_bf16_dpp v23, v35, v249 row_newbcast:6 row_mask:0xf bank_mask:0xf
  v_dot2c_f32_bf16_dpp v24, v34, v250 row_newbcast:6 row_mask:0xf bank_mask:0xf
  v_dot2c_f32_bf16_dpp v25, v35, v250 row_newbcast:6 row_mask:0xf bank_mask:0xf
  v_dot2c_f32_bf16_dpp v26, v34, v251 row_newbcast:6 row_mask:0xf bank_mask:0xf
  v_dot2c_f32_bf16_dpp v27, v35, v251 row_newbcast:6 row_mask:0xf bank_mask:0xf
  s_waitcnt vmcnt(32)
  v_dot2c_f32_bf16_dpp v20, v34, v252 row_newbcast:14 row_mask:0xf bank_mask:0xf
  v_dot2c_f32_bf16_dpp v21, v35, v252 row_newbcast:14 row_mask:0xf bank_mask:0xf
  v_dot2c_f32_bf16_dpp v22, v34, v253 row_newbcast:14 row_mask:0xf bank_mask:0xf
  v_dot2c_f32_bf16_dpp v23, v35, v253 row_newbcast:14 row_mask:0xf bank_mask:0xf
  v_dot2c_f32_bf16_dpp v24, v34, v254 row_newbcast:14 row_mask:0xf bank_mask:0xf
  v_dot2c_f32_bf16_dpp v25, v35, v254 row_newbcast:14 row_mask:0xf bank_mask:0xf
  v_dot2c_f32_bf16_dpp v26, v34, v255 row_newbcast:14 row_mask:0xf bank_mask:0xf
  v_dot2c_f32_bf16_dpp v27, v35, v255 row_newbcast:14 row_mask:0xf bank_mask:0xf
  ds_read_b32 v30, v42
  v_add_u32 v42, 128, v42
  s_waitcnt lgkmcnt(0)
  v_max_f32_dpp v31, v30, v30 row_ror:8 row_mask:0xf bank_mask:0xf
  s_nop 1
  v_max_f32_dpp v31, v31, v31 row_half_mirror row_mask:0xf bank_mask:0xf
  s_nop 1
  v_max_f32_dpp v31, v31, v31 quad_perm:[2,3,0,1] row_mask:0xf bank_mask:0xf
  v_max_f32 v31, v31, v28
  v_sub_f32 v33, v28, v31
  v_sub_f32 v30, v30, v31
  v_mov_b32 v28, v31
  v_mul_f32 v33, s53, v33
  v_mul_f32 v30, s53, v30
  v_exp_f32 v33, v33
  v_exp_f32 v30, v30
  v_mul_f32 v20, v20, v33
  v_mul_f32 v21, v21, v33
  v_mul_f32 v22, v22, v33
  v_mul_f32 v23, v23, v33
  v_mul_f32 v24, v24, v33
  v_mul_f32 v25, v25, v33
  v_mul_f32 v26, v26, v33
  v_mul_f32 v27, v27, v33
  v_fma_f32 v29, v29, v33, v30
  v_cvt_pk_bf16_f32 v34, v30, 0
  v_cvt_pk_bf16_f32 v35, 0, v30
  s_waitcnt vmcnt(31)
  v_dot2c_f32_bf16_dpp v20, v34, v64 row_newbcast:0 row_mask:0xf bank_mask:0xf
  v_dot2c_f32_bf16_dpp v21, v35, v64 row_newbcast:0 row_mask:0xf bank_mask:0xf
  v_dot2c_f32_bf16_dpp v22, v34, v65 row_newbcast:0 row_mask:0xf bank_mask:0xf
  v_dot2c_f32_bf16_dpp v23, v35, v65 row_newbcast:0 row_mask:0xf bank_mask:0xf
  v_dot2c_f32_bf16_dpp v24, v34, v66 row_newbcast:0 row_mask:0xf bank_mask:0xf
  v_dot2c_f32_bf16_dpp v25, v35, v66 row_newbcast:0 row_mask:0xf bank_mask:0xf
  v_dot2c_f32_bf16_dpp v26, v34, v67 row_newbcast:0 row_mask:0xf bank_mask:0xf
  v_dot2c_f32_bf16_dpp v27, v35, v67 row_newbcast:0 row_mask:0xf bank_mask:0xf
  s_waitcnt vmcnt(30)
  v_dot2c_f32_bf16_dpp v20, v34, v68 row_newbcast:8 row_mask:0xf bank_mask:0xf
  v_dot2c_f32_bf16_dpp v21, v35, v68 row_newbcast:8 row_mask:0xf bank_mask:0xf
  v_dot2c_f32_bf16_dpp v22, v34, v69 row_newbcast:8 row_mask:0xf bank_mask:0xf
  v_dot2c_f32_bf16_dpp v23, v35, v69 row_newbcast:8 row_mask:0xf bank_mask:0xf
  v_dot2c_f32_bf16_dpp v24, v34, v70 row_newbcast:8 row_mask:0xf bank_mask:0xf
  v_dot2c_f32_bf16_dpp v25, v35, v70 row_newbcast:8 row_mask:0xf bank_mask:0xf
  v_dot2c_f32_bf16_dpp v26, v34, v71 row_newbcast:8 row_mask:0xf bank_mask:0xf
  v_dot2c_f32_bf16_dpp v27, v35, v71 row_newbcast:8 row_mask:0xf bank_mask:0xf
  s_waitcnt vmcnt(29)
  v_dot2c_f32_bf16_dpp v20, v34, v72 row_newbcast:4 row_mask:0xf bank_mask:0xf
  v_dot2c_f32_bf16_dpp v21, v35, v72 row_newbcast:4 row_mask:0xf bank_mask:0xf
  v_dot2c_f32_bf16_dpp v22, v34, v73 row_newbcast:4 row_mask:0xf bank_mask:0xf
  v_dot2c_f32_bf16_dpp v23, v35, v73 row_newbcast:4 row_mask:0xf bank_mask:0xf
  v_dot2c_f32_bf16_dpp v24, v34, v74 row_newbcast:4 row_mask:0xf bank_mask:0xf
  v_dot2c_f32_bf16_dpp v25, v35, v74 row_newbcast:4 row_mask:0xf bank_mask:0xf
  v_dot2c_f32_bf16_dpp v26, v34, v75 row_newbcast:4 row_mask:0xf bank_mask:0xf
  v_dot2c_f32_bf16_dpp v27, v35, v75 row_newbcast:4 row_mask:0xf bank_mask:0xf
  s_waitcnt vmcnt(28)
  v_dot2c_f32_bf16_dpp v20, v34, v76 row_newbcast:12 row_mask:0xf bank_mask:0xf
  v_dot2c_f32_bf16_dpp v21, v35, v76 row_newbcast:12 row_mask:0xf bank_mask:0xf
  v_dot2c_f32_bf16_dpp v22, v34, v77 row_newbcast:12 row_mask:0xf bank_mask:0xf
  v_dot2c_f32_bf16_dpp v23, v35, v77 row_newbcast:12 row_mask:0xf bank_mask:0xf
  v_dot2c_f32_bf16_dpp v24, v34, v78 row_newbcast:12 row_mask:0xf bank_mask:0xf
  v_dot2c_f32_bf16_dpp v25, v35, v78 row_newbcast:12 row_mask:0xf bank_mask:0xf
  v_dot2c_f32_bf16_dpp v26, v34, v79 row_newbcast:12 row_mask:0xf bank_mask:0xf
  v_dot2c_f32_bf16_dpp v27, v35, v79 row_newbcast:12 row_mask:0xf bank_mask:0xf
  s_waitcnt vmcnt(27)
  v_dot2c_f32_bf16_dpp v20, v34, v80 row_newbcast:2 row_mask:0xf bank_mask:0xf
  v_dot2c_f32_bf16_dpp v21, v35, v80 row_newbcast:2 row_mask:0xf bank_mask:0xf
  v_dot2c_f32_bf16_dpp v22, v34, v81 row_newbcast:2 row_mask:0xf bank_mask:0xf
  v_dot2c_f32_bf16_dpp v23, v35, v81 row_newbcast:2 row_mask:0xf bank_mask:0xf
  v_dot2c_f32_bf16_dpp v24, v34, v82 row_newbcast:2 row_mask:0xf bank_mask:0xf
  v_dot2c_f32_bf16_dpp v25, v35, v82 row_newbcast:2 row_mask:0xf bank_mask:0xf
  v_dot2c_f32_bf16_dpp v26, v34, v83 row_newbcast:2 row_mask:0xf bank_mask:0xf
  v_dot2c_f32_bf16_dpp v27, v35, v83 row_newbcast:2 row_mask:0xf bank_mask:0xf
  s_waitcnt vmcnt(26)
  v_dot2c_f32_bf16_dpp v20, v34, v84 row_newbcast:10 row_mask:0xf bank_mask:0xf
  v_dot2c_f32_bf16_dpp v21, v35, v84 row_newbcast:10 row_mask:0xf bank_mask:0xf
  v_dot2c_f32_bf16_dpp v22, v34, v85 row_newbcast:10 row_mask:0xf bank_mask:0xf
  v_dot2c_f32_bf16_dpp v23, v35, v85 row_newbcast:10 row_mask:0xf bank_mask:0xf
  v_dot2c_f32_bf16_dpp v24, v34, v86 row_newbcast:10 row_mask:0xf bank_mask:0xf
  v_dot2c_f32_bf16_dpp v25, v35, v86 row_newbcast:10 row_mask:0xf bank_mask:0xf
  v_dot2c_f32_bf16_dpp v26, v34, v87 row_newbcast:10 row_mask:0xf bank_mask:0xf
  v_dot2c_f32_bf16_dpp v27, v35, v87 row_newbcast:10 row_mask:0xf bank_mask:0xf
  s_waitcnt vmcnt(25)
  v_dot2c_f32_bf16_dpp v20, v34, v88 row_newbcast:6 row_mask:0xf bank_mask:0xf
  v_dot2c_f32_bf16_dpp v21, v35, v88 row_newbcast:6 row_mask:0xf bank_mask:0xf
  v_dot2c_f32_bf16_dpp v22, v34, v89 row_newbcast:6 row_mask:0xf bank_mask:0xf
  v_dot2c_f32_bf16_dpp v23, v35, v89 row_newbcast:6 row_mask:0xf bank_mask:0xf
  v_dot2c_f32_bf16_dpp v24, v34, v90 row_newbcast:6 row_mask:0xf bank_mask:0xf
  v_dot2c_f32_bf16_dpp v25, v35, v90 row_newbcast:6 row_mask:0xf bank_mask:0xf
  v_dot2c_f32_bf16_dpp v26, v34, v91 row_newbcast:6 row_mask:0xf bank_mask:0xf
  v_dot2c_f32_bf16_dpp v27, v35, v91 row_newbcast:6 row_mask:0xf bank_mask:0xf
  s_waitcnt vmcnt(24)
  v_dot2c_f32_bf16_dpp v20, v34, v92 row_newbcast:14 row_mask:0xf bank_mask:0xf
  v_dot2c_f32_bf16_dpp v21, v35, v92 row_newbcast:14 row_mask:0xf bank_mask:0xf
  v_dot2c_f32_bf16_dpp v22, v34, v93 row_newbcast:14 row_mask:0xf bank_mask:0xf
  v_dot2c_f32_bf16_dpp v23, v35, v93 row_newbcast:14 row_mask:0xf bank_mask:0xf
  v_dot2c_f32_bf16_dpp v24, v34, v94 row_newbcast:14 row_mask:0xf bank_mask:0xf
  v_dot2c_f32_bf16_dpp v25, v35, v94 row_newbcast:14 row_mask:0xf bank_mask:0xf
  v_dot2c_f32_bf16_dpp v26, v34, v95 row_newbcast:14 row_mask:0xf bank_mask:0xf
  v_dot2c_f32_bf16_dpp v27, v35, v95 row_newbcast:14 row_mask:0xf bank_mask:0xf
  ds_read_b32 v30, v42
  v_add_u32 v42, 128, v42
  s_waitcnt lgkmcnt(0)
  v_max_f32_dpp v31, v30, v30 row_ror:8 row_mask:0xf bank_mask:0xf
  s_nop 1
  v_max_f32_dpp v31, v31, v31 row_half_mirror row_mask:0xf bank_mask:0xf
  s_nop 1
  v_max_f32_dpp v31, v31, v31 quad_perm:[2,3,0,1] row_mask:0xf bank_mask:0xf
  v_max_f32 v31, v31, v28
  v_sub_f32 v33, v28, v31
  v_sub_f32 v30, v30, v31
  v_mov_b32 v28, v31
  v_mul_f32 v33, s53, v33
  v_mul_f32 v30, s53, v30
  v_exp_f32 v33, v33
  v_exp_f32 v30, v30
  v_mul_f32 v20, v20, v33
  v_mul_f32 v21, v21, v33
  v_mul_f32 v22, v22, v33
  v_mul_f32 v23, v23, v33
  v_mul_f32 v24, v24, v33
  v_mul_f32 v25, v25, v33
  v_mul_f32 v26, v26, v33
  v_mul_f32 v27, v27, v33
  v_fma_f32 v29, v29, v33, v30
  v_cvt_pk_bf16_f32 v34, v30, 0
  v_cvt_pk_bf16_f32 v35, 0, v30
  s_waitcnt vmcnt(23)
  v_dot2c_f32_bf16_dpp v20, v34, v96 row_newbcast:0 row_mask:0xf bank_mask:0xf
  v_dot2c_f32_bf16_dpp v21, v35, v96 row_newbcast:0 row_mask:0xf bank_mask:0xf
  v_dot2c_f32_bf16_dpp v22, v34, v97 row_newbcast:0 row_mask:0xf bank_mask:0xf
  v_dot2c_f32_bf16_dpp v23, v35, v97 row_newbcast:0 row_mask:0xf bank_mask:0xf
  v_dot2c_f32_bf16_dpp v24, v34, v98 row_newbcast:0 row_mask:0xf bank_mask:0xf
  v_dot2c_f32_bf16_dpp v25, v35, v98 row_newbcast:0 row_mask:0xf bank_mask:0xf
  v_dot2c_f32_bf16_dpp v26, v34, v99 row_newbcast:0 row_mask:0xf bank_mask:0xf
  v_dot2c_f32_bf16_dpp v27, v35, v99 row_newbcast:0 row_mask:0xf bank_mask:0xf
  s_waitcnt vmcnt(22)
  v_dot2c_f32_bf16_dpp v20, v34, v100 row_newbcast:8 row_mask:0xf bank_mask:0xf
  v_dot2c_f32_bf16_dpp v21, v35, v100 row_newbcast:8 row_mask:0xf bank_mask:0xf
  v_dot2c_f32_bf16_dpp v22, v34, v101 row_newbcast:8 row_mask:0xf bank_mask:0xf
  v_dot2c_f32_bf16_dpp v23, v35, v101 row_newbcast:8 row_mask:0xf bank_mask:0xf
  v_dot2c_f32_bf16_dpp v24, v34, v102 row_newbcast:8 row_mask:0xf bank_mask:0xf
  v_dot2c_f32_bf16_dpp v25, v35, v102 row_newbcast:8 row_mask:0xf bank_mask:0xf
  v_dot2c_f32_bf16_dpp v26, v34, v103 row_newbcast:8 row_mask:0xf bank_mask:0xf
  v_dot2c_f32_bf16_dpp v27, v35, v103 row_newbcast:8 row_mask:0xf bank_mask:0xf
  s_waitcnt vmcnt(21)
  v_dot2c_f32_bf16_dpp v20, v34, v104 row_newbcast:4 row_mask:0xf bank_mask:0xf
  v_dot2c_f32_bf16_dpp v21, v35, v104 row_newbcast:4 row_mask:0xf bank_mask:0xf
  v_dot2c_f32_bf16_dpp v22, v34, v105 row_newbcast:4 row_mask:0xf bank_mask:0xf
  v_dot2c_f32_bf16_dpp v23, v35, v105 row_newbcast:4 row_mask:0xf bank_mask:0xf
  v_dot2c_f32_bf16_dpp v24, v34, v106 row_newbcast:4 row_mask:0xf bank_mask:0xf
  v_dot2c_f32_bf16_dpp v25, v35, v106 row_newbcast:4 row_mask:0xf bank_mask:0xf
  v_dot2c_f32_bf16_dpp v26, v34, v107 row_newbcast:4 row_mask:0xf bank_mask:0xf
  v_dot2c_f32_bf16_dpp v27, v35, v107 row_newbcast:4 row_mask:0xf bank_mask:0xf
  s_waitcnt vmcnt(20)
  v_dot2c_f32_bf16_dpp v20, v34, v108 row_newbcast:12 row_mask:0xf bank_mask:0xf
  v_dot2c_f32_bf16_dpp v21, v35, v108 row_newbcast:12 row_mask:0xf bank_mask:0xf
  v_dot2c_f32_bf16_dpp v22, v34, v109 row_newbcast:12 row_mask:0xf bank_mask:0xf
  v_dot2c_f32_bf16_dpp v23, v35, v109 row_newbcast:12 row_mask:0xf bank_mask:0xf
  v_dot2c_f32_bf16_dpp v24, v34, v110 row_newbcast:12 row_mask:0xf bank_mask:0xf
  v_dot2c_f32_bf16_dpp v25, v35, v110 row_newbcast:12 row_mask:0xf bank_mask:0xf
  v_dot2c_f32_bf16_dpp v26, v34, v111 row_newbcast:12 row_mask:0xf bank_mask:0xf
  v_dot2c_f32_bf16_dpp v27, v35, v111 row_newbcast:12 row_mask:0xf bank_mask:0xf
  s_waitcnt vmcnt(19)
  v_dot2c_f32_bf16_dpp v20, v34, v112 row_newbcast:2 row_mask:0xf bank_mask:0xf
  v_dot2c_f32_bf16_dpp v21, v35, v112 row_newbcast:2 row_mask:0xf bank_mask:0xf
  v_dot2c_f32_bf16_dpp v22, v34, v113 row_newbcast:2 row_mask:0xf bank_mask:0xf
  v_dot2c_f32_bf16_dpp v23, v35, v113 row_newbcast:2 row_mask:0xf bank_mask:0xf
  v_dot2c_f32_bf16_dpp v24, v34, v114 row_newbcast:2 row_mask:0xf bank_mask:0xf
  v_dot2c_f32_bf16_dpp v25, v35, v114 row_newbcast:2 row_mask:0xf bank_mask:0xf
  v_dot2c_f32_bf16_dpp v26, v34, v115 row_newbcast:2 row_mask:0xf bank_mask:0xf
  v_dot2c_f32_bf16_dpp v27, v35, v115 row_newbcast:2 row_mask:0xf bank_mask:0xf
  s_waitcnt vmcnt(18)
  v_dot2c_f32_bf16_dpp v20, v34, v116 row_newbcast:10 row_mask:0xf bank_mask:0xf
  v_dot2c_f32_bf16_dpp v21, v35, v116 row_newbcast:10 row_mask:0xf bank_mask:0xf
  v_dot2c_f32_bf16_dpp v22, v34, v117 row_newbcast:10 row_mask:0xf bank_mask:0xf
  v_dot2c_f32_bf16_dpp v23, v35, v117 row_newbcast:10 row_mask:0xf bank_mask:0xf
  v_dot2c_f32_bf16_dpp v24, v34, v118 row_newbcast:10 row_mask:0xf bank_mask:0xf
  v_dot2c_f32_bf16_dpp v25, v35, v118 row_newbcast:10 row_mask:0xf bank_mask:0xf
  v_dot2c_f32_bf16_dpp v26, v34, v119 row_newbcast:10 row_mask:0xf bank_mask:0xf
  v_dot2c_f32_bf16_dpp v27, v35, v119 row_newbcast:10 row_mask:0xf bank_mask:0xf
  s_waitcnt vmcnt(17)
  v_dot2c_f32_bf16_dpp v20, v34, v120 row_newbcast:6 row_mask:0xf bank_mask:0xf
  v_dot2c_f32_bf16_dpp v21, v35, v120 row_newbcast:6 row_mask:0xf bank_mask:0xf
  v_dot2c_f32_bf16_dpp v22, v34, v121 row_newbcast:6 row_mask:0xf bank_mask:0xf
  v_dot2c_f32_bf16_dpp v23, v35, v121 row_newbcast:6 row_mask:0xf bank_mask:0xf
  v_dot2c_f32_bf16_dpp v24, v34, v122 row_newbcast:6 row_mask:0xf bank_mask:0xf
  v_dot2c_f32_bf16_dpp v25, v35, v122 row_newbcast:6 row_mask:0xf bank_mask:0xf
  v_dot2c_f32_bf16_dpp v26, v34, v123 row_newbcast:6 row_mask:0xf bank_mask:0xf
  v_dot2c_f32_bf16_dpp v27, v35, v123 row_newbcast:6 row_mask:0xf bank_mask:0xf
  s_waitcnt vmcnt(16)
  v_dot2c_f32_bf16_dpp v20, v34, v124 row_newbcast:14 row_mask:0xf bank_mask:0xf
  v_dot2c_f32_bf16_dpp v21, v35, v124 row_newbcast:14 row_mask:0xf bank_mask:0xf
  v_dot2c_f32_bf16_dpp v22, v34, v125 row_newbcast:14 row_mask:0xf bank_mask:0xf
  v_dot2c_f32_bf16_dpp v23, v35, v125 row_newbcast:14 row_mask:0xf bank_mask:0xf
  v_dot2c_f32_bf16_dpp v24, v34, v126 row_newbcast:14 row_mask:0xf bank_mask:0xf
  v_dot2c_f32_bf16_dpp v25, v35, v126 row_newbcast:14 row_mask:0xf bank_mask:0xf
  v_dot2c_f32_bf16_dpp v26, v34, v127 row_newbcast:14 row_mask:0xf bank_mask:0xf
  v_dot2c_f32_bf16_dpp v27, v35, v127 row_newbcast:14 row_mask:0xf bank_mask:0xf
  ds_read_b32 v30, v42
  v_add_u32 v42, 128, v42
  s_waitcnt lgkmcnt(0)
  v_max_f32_dpp v31, v30, v30 row_ror:8 row_mask:0xf bank_mask:0xf
  s_nop 1
  v_max_f32_dpp v31, v31, v31 row_half_mirror row_mask:0xf bank_mask:0xf
  s_nop 1
  v_max_f32_dpp v31, v31, v31 quad_perm:[2,3,0,1] row_mask:0xf bank_mask:0xf
  v_max_f32 v31, v31, v28
  v_sub_f32 v33, v28, v31
  v_sub_f32 v30, v30, v31
  v_mov_b32 v28, v31
  v_mul_f32 v33, s53, v33
  v_mul_f32 v30, s53, v30
  v_exp_f32 v33, v33
  v_exp_f32 v30, v30
  v_mul_f32 v20, v20, v33
  v_mul_f32 v21, v21, v33
  v_mul_f32 v22, v22, v33
  v_mul_f32 v23, v23, v33
  v_mul_f32 v24, v24, v33
  v_mul_f32 v25, v25, v33
  v_mul_f32 v26, v26, v33
  v_mul_f32 v27, v27, v33
  v_fma_f32 v29, v29, v33, v30
  v_cvt_pk_bf16_f32 v34, v30, 0
  v_cvt_pk_bf16_f32 v35, 0, v30
  s_waitcnt vmcnt(15)
  v_dot2c_f32_bf16_dpp v20, v34, v128 row_newbcast:0 row_mask:0xf bank_mask:0xf
  v_dot2c_f32_bf16_dpp v21, v35, v128 row_newbcast:0 row_mask:0xf bank_mask:0xf
  v_dot2c_f32_bf16_dpp v22, v34, v129 row_newbcast:0 row_mask:0xf bank_mask:0xf
  v_dot2c_f32_bf16_dpp v23, v35, v129 row_newbcast:0 row_mask:0xf bank_mask:0xf
  v_dot2c_f32_bf16_dpp v24, v34, v130 row_newbcast:0 row_mask:0xf bank_mask:0xf
  v_dot2c_f32_bf16_dpp v25, v35, v130 row_newbcast:0 row_mask:0xf bank_mask:0xf
  v_dot2c_f32_bf16_dpp v26, v34, v131 row_newbcast:0 row_mask:0xf bank_mask:0xf
  v_dot2c_f32_bf16_dpp v27, v35, v131 row_newbcast:0 row_mask:0xf bank_mask:0xf
  s_waitcnt vmcnt(14)
  v_dot2c_f32_bf16_dpp v20, v34, v132 row_newbcast:8 row_mask:0xf bank_mask:0xf
  v_dot2c_f32_bf16_dpp v21, v35, v132 row_newbcast:8 row_mask:0xf bank_mask:0xf
  v_dot2c_f32_bf16_dpp v22, v34, v133 row_newbcast:8 row_mask:0xf bank_mask:0xf
  v_dot2c_f32_bf16_dpp v23, v35, v133 row_newbcast:8 row_mask:0xf bank_mask:0xf
  v_dot2c_f32_bf16_dpp v24, v34, v134 row_newbcast:8 row_mask:0xf bank_mask:0xf
  v_dot2c_f32_bf16_dpp v25, v35, v134 row_newbcast:8 row_mask:0xf bank_mask:0xf
  v_dot2c_f32_bf16_dpp v26, v34, v135 row_newbcast:8 row_mask:0xf bank_mask:0xf
  v_dot2c_f32_bf16_dpp v27, v35, v135 row_newbcast:8 row_mask:0xf bank_mask:0xf
  s_waitcnt vmcnt(13)
  v_dot2c_f32_bf16_dpp v20, v34, v136 row_newbcast:4 row_mask:0xf bank_mask:0xf
  v_dot2c_f32_bf16_dpp v21, v35, v136 row_newbcast:4 row_mask:0xf bank_mask:0xf
  v_dot2c_f32_bf16_dpp v22, v34, v137 row_newbcast:4 row_mask:0xf bank_mask:0xf
  v_dot2c_f32_bf16_dpp v23, v35, v137 row_newbcast:4 row_mask:0xf bank_mask:0xf
  v_dot2c_f32_bf16_dpp v24, v34, v138 row_newbcast:4 row_mask:0xf bank_mask:0xf
  v_dot2c_f32_bf16_dpp v25, v35, v138 row_newbcast:4 row_mask:0xf bank_mask:0xf
  v_dot2c_f32_bf16_dpp v26, v34, v139 row_newbcast:4 row_mask:0xf bank_mask:0xf
  v_dot2c_f32_bf16_dpp v27, v35, v139 row_newbcast:4 row_mask:0xf bank_mask:0xf
  s_waitcnt vmcnt(12)
  v_dot2c_f32_bf16_dpp v20, v34, v140 row_newbcast:12 row_mask:0xf bank_mask:0xf
  v_dot2c_f32_bf16_dpp v21, v35, v140 row_newbcast:12 row_mask:0xf bank_mask:0xf
  v_dot2c_f32_bf16_dpp v22, v34, v141 row_newbcast:12 row_mask:0xf bank_mask:0xf
  v_dot2c_f32_bf16_dpp v23, v35, v141 row_newbcast:12 row_mask:0xf bank_mask:0xf
  v_dot2c_f32_bf16_dpp v24, v34, v142 row_newbcast:12 row_mask:0xf bank_mask:0xf
  v_dot2c_f32_bf16_dpp v25, v35, v142 row_newbcast:12 row_mask:0xf bank_mask:0xf
  v_dot2c_f32_bf16_dpp v26, v34, v143 row_newbcast:12 row_mask:0xf bank_mask:0xf
  v_dot2c_f32_bf16_dpp v27, v35, v143 row_newbcast:12 row_mask:0xf bank_mask:0xf
  s_waitcnt vmcnt(11)
  v_dot2c_f32_bf16_dpp v20, v34, v144 row_newbcast:2 row_mask:0xf bank_mask:0xf
  v_dot2c_f32_bf16_dpp v21, v35, v144 row_newbcast:2 row_mask:0xf bank_mask:0xf
  v_dot2c_f32_bf16_dpp v22, v34, v145 row_newbcast:2 row_mask:0xf bank_mask:0xf
  v_dot2c_f32_bf16_dpp v23, v35, v145 row_newbcast:2 row_mask:0xf bank_mask:0xf
  v_dot2c_f32_bf16_dpp v24, v34, v146 row_newbcast:2 row_mask:0xf bank_mask:0xf
  v_dot2c_f32_bf16_dpp v25, v35, v146 row_newbcast:2 row_mask:0xf bank_mask:0xf
  v_dot2c_f32_bf16_dpp v26, v34, v147 row_newbcast:2 row_mask:0xf bank_mask:0xf
  v_dot2c_f32_bf16_dpp v27, v35, v147 row_newbcast:2 row_mask:0xf bank_mask:0xf
  s_waitcnt vmcnt(10)
  v_dot2c_f32_bf16_dpp v20, v34, v148 row_newbcast:10 row_mask:0xf bank_mask:0xf
  v_dot2c_f32_bf16_dpp v21, v35, v148 row_newbcast:10 row_mask:0xf bank_mask:0xf
  v_dot2c_f32_bf16_dpp v22, v34, v149 row_newbcast:10 row_mask:0xf bank_mask:0xf
  v_dot2c_f32_bf16_dpp v23, v35, v149 row_newbcast:10 row_mask:0xf bank_mask:0xf
  v_dot2c_f32_bf16_dpp v24, v34, v150 row_newbcast:10 row_mask:0xf bank_mask:0xf
  v_dot2c_f32_bf16_dpp v25, v35, v150 row_newbcast:10 row_mask:0xf bank_mask:0xf
  v_dot2c_f32_bf16_dpp v26, v34, v151 row_newbcast:10 row_mask:0xf bank_mask:0xf
  v_dot2c_f32_bf16_dpp v27, v35, v151 row_newbcast:10 row_mask:0xf bank_mask:0xf
  s_waitcnt vmcnt(9)
  v_dot2c_f32_bf16_dpp v20, v34, v152 row_newbcast:6 row_mask:0xf bank_mask:0xf
  v_dot2c_f32_bf16_dpp v21, v35, v152 row_newbcast:6 row_mask:0xf bank_mask:0xf
  v_dot2c_f32_bf16_dpp v22, v34, v153 row_newbcast:6 row_mask:0xf bank_mask:0xf
  v_dot2c_f32_bf16_dpp v23, v35, v153 row_newbcast:6 row_mask:0xf bank_mask:0xf
  v_dot2c_f32_bf16_dpp v24, v34, v154 row_newbcast:6 row_mask:0xf bank_mask:0xf
  v_dot2c_f32_bf16_dpp v25, v35, v154 row_newbcast:6 row_mask:0xf bank_mask:0xf
  v_dot2c_f32_bf16_dpp v26, v34, v155 row_newbcast:6 row_mask:0xf bank_mask:0xf
  v_dot2c_f32_bf16_dpp v27, v35, v155 row_newbcast:6 row_mask:0xf bank_mask:0xf
  s_waitcnt vmcnt(8)
  v_dot2c_f32_bf16_dpp v20, v34, v156 row_newbcast:14 row_mask:0xf bank_mask:0xf
  v_dot2c_f32_bf16_dpp v21, v35, v156 row_newbcast:14 row_mask:0xf bank_mask:0xf
  v_dot2c_f32_bf16_dpp v22, v34, v157 row_newbcast:14 row_mask:0xf bank_mask:0xf
  v_dot2c_f32_bf16_dpp v23, v35, v157 row_newbcast:14 row_mask:0xf bank_mask:0xf
  v_dot2c_f32_bf16_dpp v24, v34, v158 row_newbcast:14 row_mask:0xf bank_mask:0xf
  v_dot2c_f32_bf16_dpp v25, v35, v158 row_newbcast:14 row_mask:0xf bank_mask:0xf
  v_dot2c_f32_bf16_dpp v26, v34, v159 row_newbcast:14 row_mask:0xf bank_mask:0xf
  v_dot2c_f32_bf16_dpp v27, v35, v159 row_newbcast:14 row_mask:0xf bank_mask:0xf
  ds_read_b32 v30, v42
  v_add_u32 v42, 128, v42
  s_waitcnt lgkmcnt(0)
  v_max_f32_dpp v31, v30, v30 row_ror:8 row_mask:0xf bank_mask:0xf
  s_nop 1
  v_max_f32_dpp v31, v31, v31 row_half_mirror row_mask:0xf bank_mask:0xf
  s_nop 1
  v_max_f32_dpp v31, v31, v31 quad_perm:[2,3,0,1] row_mask:0xf bank_mask:0xf
  v_max_f32 v31, v31, v28
  v_sub_f32 v33, v28, v31
  v_sub_f32 v30, v30, v31
  v_mov_b32 v28, v31
  v_mul_f32 v33, s53, v33
  v_mul_f32 v30, s53, v30
  v_exp_f32 v33, v33
  v_exp_f32 v30, v30
  v_mul_f32 v20, v20, v33
  v_mul_f32 v21, v21, v33
  v_mul_f32 v22, v22, v33
  v_mul_f32 v23, v23, v33
  v_mul_f32 v24, v24, v33
  v_mul_f32 v25, v25, v33
  v_mul_f32 v26, v26, v33
  v_mul_f32 v27, v27, v33
  v_fma_f32 v29, v29, v33, v30
  v_cvt_pk_bf16_f32 v34, v30, 0
  v_cvt_pk_bf16_f32 v35, 0, v30
  s_waitcnt vmcnt(7)
  v_dot2c_f32_bf16_dpp v20, v34, v160 row_newbcast:0 row_mask:0xf bank_mask:0xf
  v_dot2c_f32_bf16_dpp v21, v35, v160 row_newbcast:0 row_mask:0xf bank_mask:0xf
  v_dot2c_f32_bf16_dpp v22, v34, v161 row_newbcast:0 row_mask:0xf bank_mask:0xf
  v_dot2c_f32_bf16_dpp v23, v35, v161 row_newbcast:0 row_mask:0xf bank_mask:0xf
  v_dot2c_f32_bf16_dpp v24, v34, v162 row_newbcast:0 row_mask:0xf bank_mask:0xf
  v_dot2c_f32_bf16_dpp v25, v35, v162 row_newbcast:0 row_mask:0xf bank_mask:0xf
  v_dot2c_f32_bf16_dpp v26, v34, v163 row_newbcast:0 row_mask:0xf bank_mask:0xf
  v_dot2c_f32_bf16_dpp v27, v35, v163 row_newbcast:0 row_mask:0xf bank_mask:0xf
  s_waitcnt vmcnt(6)
  v_dot2c_f32_bf16_dpp v20, v34, v164 row_newbcast:8 row_mask:0xf bank_mask:0xf
  v_dot2c_f32_bf16_dpp v21, v35, v164 row_newbcast:8 row_mask:0xf bank_mask:0xf
  v_dot2c_f32_bf16_dpp v22, v34, v165 row_newbcast:8 row_mask:0xf bank_mask:0xf
  v_dot2c_f32_bf16_dpp v23, v35, v165 row_newbcast:8 row_mask:0xf bank_mask:0xf
  v_dot2c_f32_bf16_dpp v24, v34, v166 row_newbcast:8 row_mask:0xf bank_mask:0xf
  v_dot2c_f32_bf16_dpp v25, v35, v166 row_newbcast:8 row_mask:0xf bank_mask:0xf
  v_dot2c_f32_bf16_dpp v26, v34, v167 row_newbcast:8 row_mask:0xf bank_mask:0xf
  v_dot2c_f32_bf16_dpp v27, v35, v167 row_newbcast:8 row_mask:0xf bank_mask:0xf
  s_waitcnt vmcnt(5)
  v_dot2c_f32_bf16_dpp v20, v34, v168 row_newbcast:4 row_mask:0xf bank_mask:0xf
  v_dot2c_f32_bf16_dpp v21, v35, v168 row_newbcast:4 row_mask:0xf bank_mask:0xf
  v_dot2c_f32_bf16_dpp v22, v34, v169 row_newbcast:4 row_mask:0xf bank_mask:0xf
  v_dot2c_f32_bf16_dpp v23, v35, v169 row_newbcast:4 row_mask:0xf bank_mask:0xf
  v_dot2c_f32_bf16_dpp v24, v34, v170 row_newbcast:4 row_mask:0xf bank_mask:0xf
  v_dot2c_f32_bf16_dpp v25, v35, v170 row_newbcast:4 row_mask:0xf bank_mask:0xf
  v_dot2c_f32_bf16_dpp v26, v34, v171 row_newbcast:4 row_mask:0xf bank_mask:0xf
  v_dot2c_f32_bf16_dpp v27, v35, v171 row_newbcast:4 row_mask:0xf bank_mask:0xf
  s_waitcnt vmcnt(4)
  v_dot2c_f32_bf16_dpp v20, v34, v172 row_newbcast:12 row_mask:0xf bank_mask:0xf
  v_dot2c_f32_bf16_dpp v21, v35, v172 row_newbcast:12 row_mask:0xf bank_mask:0xf
  v_dot2c_f32_bf16_dpp v22, v34, v173 row_newbcast:12 row_mask:0xf bank_mask:0xf
  v_dot2c_f32_bf16_dpp v23, v35, v173 row_newbcast:12 row_mask:0xf bank_mask:0xf
  v_dot2c_f32_bf16_dpp v24, v34, v174 row_newbcast:12 row_mask:0xf bank_mask:0xf
  v_dot2c_f32_bf16_dpp v25, v35, v174 row_newbcast:12 row_mask:0xf bank_mask:0xf
  v_dot2c_f32_bf16_dpp v26, v34, v175 row_newbcast:12 row_mask:0xf bank_mask:0xf
  v_dot2c_f32_bf16_dpp v27, v35, v175 row_newbcast:12 row_mask:0xf bank_mask:0xf
  s_waitcnt vmcnt(3)
  v_dot2c_f32_bf16_dpp v20, v34, v176 row_newbcast:2 row_mask:0xf bank_mask:0xf
  v_dot2c_f32_bf16_dpp v21, v35, v176 row_newbcast:2 row_mask:0xf bank_mask:0xf
  v_dot2c_f32_bf16_dpp v22, v34, v177 row_newbcast:2 row_mask:0xf bank_mask:0xf
  v_dot2c_f32_bf16_dpp v23, v35, v177 row_newbcast:2 row_mask:0xf bank_mask:0xf
  v_dot2c_f32_bf16_dpp v24, v34, v178 row_newbcast:2 row_mask:0xf bank_mask:0xf
  v_dot2c_f32_bf16_dpp v25, v35, v178 row_newbcast:2 row_mask:0xf bank_mask:0xf
  v_dot2c_f32_bf16_dpp v26, v34, v179 row_newbcast:2 row_mask:0xf bank_mask:0xf
  v_dot2c_f32_bf16_dpp v27, v35, v179 row_newbcast:2 row_mask:0xf bank_mask:0xf
  s_waitcnt vmcnt(2)
  v_dot2c_f32_bf16_dpp v20, v34, v180 row_newbcast:10 row_mask:0xf bank_mask:0xf
  v_dot2c_f32_bf16_dpp v21, v35, v180 row_newbcast:10 row_mask:0xf bank_mask:0xf
  v_dot2c_f32_bf16_dpp v22, v34, v181 row_newbcast:10 row_mask:0xf bank_mask:0xf
  v_dot2c_f32_bf16_dpp v23, v35, v181 row_newbcast:10 row_mask:0xf bank_mask:0xf
  v_dot2c_f32_bf16_dpp v24, v34, v182 row_newbcast:10 row_mask:0xf bank_mask:0xf
  v_dot2c_f32_bf16_dpp v25, v35, v182 row_newbcast:10 row_mask:0xf bank_mask:0xf
  v_dot2c_f32_bf16_dpp v26, v34, v183 row_newbcast:10 row_mask:0xf bank_mask:0xf
  v_dot2c_f32_bf16_dpp v27, v35, v183 row_newbcast:10 row_mask:0xf bank_mask:0xf
  s_waitcnt vmcnt(1)
  v_dot2c_f32_bf16_dpp v20, v34, v184 row_newbcast:6 row_mask:0xf bank_mask:0xf
  v_dot2c_f32_bf16_dpp v21, v35, v184 row_newbcast:6 row_mask:0xf bank_mask:0xf
  v_dot2c_f32_bf16_dpp v22, v34, v185 row_newbcast:6 row_mask:0xf bank_mask:0xf
  v_dot2c_f32_bf16_dpp v23, v35, v185 row_newbcast:6 row_mask:0xf bank_mask:0xf
  v_dot2c_f32_bf16_dpp v24, v34, v186 row_newbcast:6 row_mask:0xf bank_mask:0xf
  v_dot2c_f32_bf16_dpp v25, v35, v186 row_newbcast:6 row_mask:0xf bank_mask:0xf
  v_dot2c_f32_bf16_dpp v26, v34, v187 row_newbcast:6 row_mask:0xf bank_mask:0xf
  v_dot2c_f32_bf16_dpp v27, v35, v187 row_newbcast:6 row_mask:0xf bank_mask:0xf
  s_waitcnt vmcnt(0)
  v_dot2c_f32_bf16_dpp v20, v34, v188 row_newbcast:14 row_mask:0xf bank_mask:0xf
  v_dot2c_f32_bf16_dpp v21, v35, v188 row_newbcast:14 row_mask:0xf bank_mask:0xf
  v_dot2c_f32_bf16_dpp v22, v34, v189 row_newbcast:14 row_mask:0xf bank_mask:0xf
  v_dot2c_f32_bf16_dpp v23, v35, v189 row_newbcast:14 row_mask:0xf bank_mask:0xf
  v_dot2c_f32_bf16_dpp v24, v34, v190 row_newbcast:14 row_mask:0xf bank_mask:0xf
  v_dot2c_f32_bf16_dpp v25, v35, v190 row_newbcast:14 row_mask:0xf bank_mask:0xf
  v_dot2c_f32_bf16_dpp v26, v34, v191 row_newbcast:14 row_mask:0xf bank_mask:0xf
  v_dot2c_f32_bf16_dpp v27, v35, v191 row_newbcast:14 row_mask:0xf bank_mask:0xf
  v_mov_b32 v31, v28
  v_mov_b32 v32, v31
  v_mov_b32 v33, v31
  s_nop 1
  v_permlane32_swap_b32 v32, v33
  v_max_f32 v31, v32, v33
  v_mov_b32 v32, v31
  v_mov_b32 v33, v31
  s_nop 1
  v_permlane16_swap_b32 v32, v33
  v_max_f32 v31, v32, v33
  v_sub_f32 v33, v28, v31
  v_mul_f32 v33, s53, v33
  v_exp_f32 v33, v33
  v_add_f32_dpp v29, v29, v29 row_ror:8 row_mask:0xf bank_mask:0xf
  s_nop 1
  v_add_f32_dpp v29, v29, v29 row_half_mirror row_mask:0xf bank_mask:0xf
  s_nop 1
  v_add_f32_dpp v29, v29, v29 quad_perm:[2,3,0,1] row_mask:0xf bank_mask:0xf
  v_mul_f32 v29, v29, v33
  v_mul_f32 v20, v20, v33
  v_mul_f32 v21, v21, v33
  v_mul_f32 v22, v22, v33
  v_mul_f32 v23, v23, v33
  v_mul_f32 v24, v24, v33
  v_mul_f32 v25, v25, v33
  v_mul_f32 v26, v26, v33
  v_mul_f32 v27, v27, v33
  v_mov_b32 v32, v29
  v_mov_b32 v30, v29
  s_nop 1
  v_permlane32_swap_b32 v32, v30
  v_add_f32 v29, v32, v30
  v_mov_b32 v32, v29
  v_mov_b32 v30, v29
  s_nop 1
  v_permlane16_swap_b32 v32, v30
  v_add_f32 v29, v32, v30
  v_permlane32_swap_b32 v20, v24
  v_permlane32_swap_b32 v21, v25
  v_permlane32_swap_b32 v22, v26
  v_permlane32_swap_b32 v23, v27
  v_add_f32 v20, v20, v24
  v_add_f32 v21, v21, v25
  v_add_f32 v22, v22, v26
  v_add_f32 v23, v23, v27
  s_nop 0
  v_permlane16_swap_b32 v20, v22
  v_permlane16_swap_b32 v21, v23
  v_add_f32 v20, v20, v22
  v_add_f32 v21, v21, v23
  v_lshlrev_b32 v7, 3, v3
  v_add_u32 v7, v7, v6
  s_lshl_b32 s48, s3, 9
  v_add_u32 v7, s48, v7
  ds_write_b64 v7, v[20:21] offset:1024
  v_mov_b32 v36, v31
  v_mov_b32 v37, v29
  s_lshl_b32 s48, s3, 3
  v_mov_b32 v7, s48
  ds_write_b64 v7, v[36:37] offset:512
  s_waitcnt lgkmcnt(0)
  s_barrier
  s_branch A_join
A_helper:
  s_lshl_b32 s48, s3, 10
  v_add_u32 v6, s48, v5
  global_load_dwordx4 v[8:11], v6, s[4:5]
  s_lshl_b32 s48, s3, 20
  s_lshl_b32 s44, s40, 8
  s_add_u32 s48, s48, s44
  s_add_u32 s28, s10, s48
  s_addc_u32 s29, s11, 0
  s_mov_b32 s30, 0x100000
  s_mov_b32 s31, 0x20000
  v_lshlrev_b32 v7, 13, v3
  v_lshl_add_u32 v7, v4, 4, v7
  s_mov_b32 s36, 0
  buffer_load_dwordx4 v[64:67], v7, s[28:31], s36 offen
  s_add_u32 s36, s36, 32768
  buffer_load_dwordx4 v[68:71], v7, s[28:31], s36 offen
  s_add_u32 s36, s36, 32768
  buffer_load_dwordx4 v[72:75], v7, s[28:31], s36 offen
  s_add_u32 s36, s36, 32768
  buffer_load_dwordx4 v[76:79], v7, s[28:31], s36 offen
  s_add_u32 s36, s36, 32768
  v_mov_b32 v28, 0
  v_mov_b32 v29, 0
  v_mov_b32 v30, 0
  v_mov_b32 v31, 0
  v_mov_b32 v32, 0
  v_mov_b32 v33, 0
  v_mov_b32 v34, 0
  v_mov_b32 v35, 0
  s_waitcnt vmcnt(4)
  v_lshlrev_b32 v12, 16, v8
  v_and_b32 v13, 0xffff0000, v8
  v_lshlrev_b32 v14, 16, v9
  v_and_b32 v15, 0xffff0000, v9
  v_lshlrev_b32 v16, 16, v10
  v_and_b32 v17, 0xffff0000, v10
  v_lshlrev_b32 v18, 16, v11
  v_and_b32 v19, 0xffff0000, v11
  v_add_f32 v36, v12, v13
  v_add_f32 v36, v36, v14
  v_add_f32 v36, v36, v15
  s_waitcnt vmcnt(3)
  buffer_load_dwordx4 v[80:83], v7, s[28:31], s36 offen
  s_add_u32 s36, s36, 32768
  v_add_f32 v36, v36, v16
  v_add_f32 v36, v36, v17
  v_add_f32 v36, v36, v18
  v_add_f32 v36, v36, v19
  s_nop 1
  v_add_f32_dpp v36, v36, v36 quad_perm:[1,0,3,2] row_mask:0xf bank_mask:0xf
  s_nop 1
  v_add_f32_dpp v36, v36, v36 quad_perm:[2,3,0,1] row_mask:0xf bank_mask:0xf
  s_nop 1
  v_add_f32_dpp v36, v36, v36 row_half_mirror row_mask:0xf bank_mask:0xf
  s_nop 1
  v_add_f32_dpp v36, v36, v36 row_ror:8 row_mask:0xf bank_mask:0xf
  v_mov_b32 v37, v36
  v_mov_b32 v38, v36
  s_nop 1
  v_permlane32_swap_b32 v37, v38
  v_add_f32 v36, v37, v38
  s_waitcnt vmcnt(3)
  buffer_load_dwordx4 v[84:87], v7, s[28:31], s36 offen
  s_add_u32 s36, s36, 32768
  v_mov_b32 v37, v36
  v_mov_b32 v38, v36
  s_nop 1
  v_permlane16_swap_b32 v37, v38
  v_add_f32 v36, v37, v38
  v_mul_f32 v39, 0x3b000000, v36
  v_sub_f32 v37, v12, v39
  v_mul_f32 v36, v37, v37
  v_sub_f32 v37, v13, v39
  v_fmac_f32 v36, v37, v37
  v_sub_f32 v37, v14, v39
  v_fmac_f32 v36, v37, v37
  v_sub_f32 v37, v15, v39
  s_waitcnt vmcnt(3)
  buffer_load_dwordx4 v[88:91], v7, s[28:31], s36 offen
  s_add_u32 s36, s36, 32768
  v_fmac_f32 v36, v37, v37
  v_sub_f32 v37, v16, v39
  v_fmac_f32 v36, v37, v37
  v_sub_f32 v37, v17, v39
  v_fmac_f32 v36, v37, v37
  v_sub_f32 v37, v18, v39
  v_fmac_f32 v36, v37, v37
  v_sub_f32 v37, v19, v39
  v_fmac_f32 v36, v37, v37
  s_nop 1
  v_add_f32_dpp v36, v36, v36 quad_perm:[1,0,3,2] row_mask:0xf bank_mask:0xf
  s_nop 1
  v_add_f32_dpp v36, v36, v36 quad_perm:[2,3,0,1] row_mask:0xf bank_mask:0xf
  s_nop 1
  v_add_f32_dpp v36, v36, v36 row_half_mirror row_mask:0xf bank_mask:0xf
  s_waitcnt vmcnt(3)
  buffer_load_dwordx4 v[92:95], v7, s[28:31], s36 offen
  s_add_u32 s36, s36, 32768
  v_add_f32_dpp v36, v36, v36 row_ror:8 row_mask:0xf bank_mask:0xf
  v_mov_b32 v37, v36
  v_mov_b32 v38, v36
  s_nop 1
  v_permlane32_swap_b32 v37, v38
  v_add_f32 v36, v37, v38
  v_mov_b32 v37, v36
  v_mov_b32 v38, v36
  s_nop 1
  v_permlane16_swap_b32 v37, v38
  v_add_f32 v36, v37, v38
  v_mul_f32 v36, 0x3b000000, v36
  v_cvt_pk_bf16_f32 v37, v36, v36
  v_and_b32 v36, 0xffff0000, v37
  s_waitcnt vmcnt(3)
  buffer_load_dwordx4 v[96:99], v7, s[28:31], s36 offen
  s_add_u32 s36, s36, 32768
  v_add_f32 v36, 0x3727c5ac, v36
  v_cvt_pk_bf16_f32 v37, v36, v36
  v_and_b32 v36, 0xffff0000, v37
  v_sqrt_f32 v36, v36
  s_nop 0
  v_cvt_pk_bf16_f32 v37, v36, v36
  v_and_b32 v36, 0xffff0000, v37
  v_cvt_pk_bf16_f32 v37, v39, v39
  v_and_b32 v39, 0xffff0000, v37
  v_rcp_f32 v40, v36
  v_sub_f32 v12, v12, v39
  v_cvt_pk_bf16_f32 v37, v12, v12
  v_and_b32 v12, 0xffff0000, v37
  s_waitcnt vmcnt(3)
  buffer_load_dwordx4 v[100:103], v7, s[28:31], s36 offen
  s_add_u32 s36, s36, 32768
  v_mul_f32 v38, v12, v40
  v_fma_f32 v41, -v38, v36, v12
  v_fma_f32 v12, v41, v40, v38
  v_cvt_pk_bf16_f32 v37, v12, v12
  v_and_b32 v12, 0xffff0000, v37
  v_sub_f32 v13, v13, v39
  v_cvt_pk_bf16_f32 v37, v13, v13
  v_and_b32 v13, 0xffff0000, v37
  v_mul_f32 v38, v13, v40
  v_fma_f32 v41, -v38, v36, v13
  v_fma_f32 v13, v41, v40, v38
  v_cvt_pk_bf16_f32 v37, v13, v13
  s_waitcnt vmcnt(3)
  buffer_load_dwordx4 v[104:107], v7, s[28:31], s36 offen
  s_add_u32 s36, s36, 32768
  v_and_b32 v13, 0xffff0000, v37
  v_sub_f32 v14, v14, v39
  v_cvt_pk_bf16_f32 v37, v14, v14
  v_and_b32 v14, 0xffff0000, v37
  v_mul_f32 v38, v14, v40
  v_fma_f32 v41, -v38, v36, v14
  v_fma_f32 v14, v41, v40, v38
  v_cvt_pk_bf16_f32 v37, v14, v14
  v_and_b32 v14, 0xffff0000, v37
  v_sub_f32 v15, v15, v39
  v_cvt_pk_bf16_f32 v37, v15, v15
  v_and_b32 v15, 0xffff0000, v37
  s_waitcnt vmcnt(3)
  buffer_load_dwordx4 v[108:111], v7, s[28:31], s36 offen
  s_add_u32 s36, s36, 32768
  v_mul_f32 v38, v15, v40
  v_fma_f32 v41, -v38, v36, v15
  v_fma_f32 v15, v41, v40, v38
  v_cvt_pk_bf16_f32 v37, v15, v15
  v_and_b32 v15, 0xffff0000, v37
  v_sub_f32 v16, v16, v39
  v_cvt_pk_bf16_f32 v37, v16, v16
  v_and_b32 v16, 0xffff0000, v37
  v_mul_f32 v38, v16, v40
  v_fma_f32 v41, -v38, v36, v16
  v_fma_f32 v16, v41, v40, v38
  v_cvt_pk_bf16_f32 v37, v16, v16
  s_waitcnt vmcnt(3)
  buffer_load_dwordx4 v[112:115], v7, s[28:31], s36 offen
  s_add_u32 s36, s36, 32768
  v_and_b32 v16, 0xffff0000, v37
  v_sub_f32 v17, v17, v39
  v_cvt_pk_bf16_f32 v37, v17, v17
  v_and_b32 v17, 0xffff0000, v37
  v_mul_f32 v38, v17, v40
  v_fma_f32 v41, -v38, v36, v17
  v_fma_f32 v17, v41, v40, v38
  v_cvt_pk_bf16_f32 v37, v17, v17
  v_and_b32 v17, 0xffff0000, v37
  v_sub_f32 v18, v18, v39
  v_cvt_pk_bf16_f32 v37, v18, v18
  v_and_b32 v18, 0xffff0000, v37
  s_waitcnt vmcnt(3)
  buffer_load_dwordx4 v[116:119], v7, s[28:31], s36 offen
  s_add_u32 s36, s36, 32768
  v_mul_f32 v38, v18, v40
  v_fma_f32 v41, -v38, v36, v18
  v_fma_f32 v18, v41, v40, v38
  v_cvt_pk_bf16_f32 v37, v18, v18
  v_and_b32 v18, 0xffff0000, v37
  v_sub_f32 v19, v19, v39
  v_cvt_pk_bf16_f32 v37, v19, v19
  v_and_b32 v19, 0xffff0000, v37
  v_mul_f32 v38, v19, v40
  v_fma_f32 v41, -v38, v36, v19
  v_fma_f32 v19, v41, v40, v38
  v_cvt_pk_bf16_f32 v37, v19, v19
  v_and_b32 v19, 0xffff0000, v37
  s_lshl_b32 s48, s3, 11
  v_lshl_add_u32 v6, v1, 5, s48
  ds_write_b128 v6, v[12:15] offset:3072
  ds_write_b128 v6, v[16:19] offset:3088
  s_waitcnt vmcnt(3)
  buffer_load_dwordx4 v[120:123], v7, s[28:31], s36 offen
  s_add_u32 s36, s36, 32768
  s_waitcnt lgkmcnt(0)
  s_mov_b64 exec, 1
  ds_add_u32 v60, v61 offset:0
  s_mov_b64 exec, -1
H_sync1:
  ds_read_b32 v62, v60 offset:0
  s_waitcnt lgkmcnt(0)
  v_readfirstlane_b32 s48, v62
  s_nop 1
  s_cmp_lt_u32 s48, 4
  s_cbranch_scc1 H_sync1
  s_lshl_b32 s48, s41, 11
  s_lshl_b32 s44, s3, 9
  s_add_u32 s48, s48, s44
  v_lshl_add_u32 v6, v3, 2, s48
  ds_read_b32 v192, v6 offset:3072
  ds_read_b32 v193, v6 offset:3088
  ds_read_b32 v194, v6 offset:3104
  ds_read_b32 v195, v6 offset:3120
  ds_read_b32 v196, v6 offset:3136
  ds_read_b32 v197, v6 offset:3152
  ds_read_b32 v198, v6 offset:3168
  ds_read_b32 v199, v6 offset:3184
  ds_read_b32 v200, v6 offset:3200
  ds_read_b32 v201, v6 offset:3216
  ds_read_b32 v202, v6 offset:3232
  ds_read_b32 v203, v6 offset:3248
  ds_read_b32 v204, v6 offset:3264
  ds_read_b32 v205, v6 offset:3280
  ds_read_b32 v206, v6 offset:3296
  ds_read_b32 v207, v6 offset:3312
  ds_read_b32 v208, v6 offset:3328
  ds_read_b32 v209, v6 offset:3344
  ds_read_b32 v210, v6 offset:3360
  ds_read_b32 v211, v6 offset:3376
  ds_read_b32 v212, v6 offset:3392
  ds_read_b32 v213, v6 offset:3408
  ds_read_b32 v214, v6 offset:3424
  ds_read_b32 v215, v6 offset:3440
  ds_read_b32 v216, v6 offset:3456
  ds_read_b32 v217, v6 offset:3472
  ds_read_b32 v218, v6 offset:3488
  ds_read_b32 v219, v6 offset:3504
  ds_read_b32 v220, v6 offset:3520
  ds_read_b32 v221, v6 offset:3536
  ds_read_b32 v222, v6 offset:3552
  ds_read_b32 v223, v6 offset:3568
  s_waitcnt vmcnt(3)
  buffer_load_dwordx4 v[124:127], v7, s[28:31], s36 offen
  s_add_u32 s36, s36, 32768
  s_waitcnt lgkmcnt(0)
  s_waitcnt vmcnt(3)
  buffer_load_dwordx4 v[128:131], v7, s[28:31], s36 offen
  s_add_u32 s36, s36, 32768
  s_waitcnt vmcnt(16)
  v_lshrrev_b32 v36, 16, v192
  v_dot2c_f32_bf16 v28, v36, v64
  v_dot2c_f32_bf16 v29, v192, v64
  v_dot2c_f32_bf16 v30, v36, v65
  v_dot2c_f32_bf16 v31, v192, v65
  v_dot2c_f32_bf16 v32, v36, v66
  v_dot2c_f32_bf16 v33, v192, v66
  v_dot2c_f32_bf16 v34, v36, v67
  v_dot2c_f32_bf16 v35, v192, v67
  s_waitcnt vmcnt(3)
  buffer_load_dwordx4 v[132:135], v7, s[28:31], s36 offen
  s_add_u32 s36, s36, 32768
  s_waitcnt vmcnt(16)
  v_lshrrev_b32 v36, 16, v193
  v_dot2c_f32_bf16 v28, v36, v68
  v_dot2c_f32_bf16 v29, v193, v68
  v_dot2c_f32_bf16 v30, v36, v69
  v_dot2c_f32_bf16 v31, v193, v69
  v_dot2c_f32_bf16 v32, v36, v70
  v_dot2c_f32_bf16 v33, v193, v70
  v_dot2c_f32_bf16 v34, v36, v71
  v_dot2c_f32_bf16 v35, v193, v71
  s_waitcnt vmcnt(3)
  buffer_load_dwordx4 v[136:139], v7, s[28:31], s36 offen
  s_add_u32 s36, s36, 32768
  s_waitcnt vmcnt(16)
  v_lshrrev_b32 v36, 16, v194
  v_dot2c_f32_bf16 v28, v36, v72
  v_dot2c_f32_bf16 v29, v194, v72
  v_dot2c_f32_bf16 v30, v36, v73
  v_dot2c_f32_bf16 v31, v194, v73
  v_dot2c_f32_bf16 v32, v36, v74
  v_dot2c_f32_bf16 v33, v194, v74
  v_dot2c_f32_bf16 v34, v36, v75
  v_dot2c_f32_bf16 v35, v194, v75
  s_waitcnt vmcnt(3)
  buffer_load_dwordx4 v[140:143], v7, s[28:31], s36 offen
  s_add_u32 s36, s36, 32768
  s_waitcnt vmcnt(16)
  v_lshrrev_b32 v36, 16, v195
  v_dot2c_f32_bf16 v28, v36, v76
  v_dot2c_f32_bf16 v29, v195, v76
  v_dot2c_f32_bf16 v30, v36, v77
  v_dot2c_f32_bf16 v31, v195, v77
  v_dot2c_f32_bf16 v32, v36, v78
  v_dot2c_f32_bf16 v33, v195, v78
  v_dot2c_f32_bf16 v34, v36, v79
  v_dot2c_f32_bf16 v35, v195, v79
  s_waitcnt vmcnt(3)
  buffer_load_dwordx4 v[144:147], v7, s[28:31], s36 offen
  s_add_u32 s36, s36, 32768
  s_waitcnt vmcnt(16)
  v_lshrrev_b32 v36, 16, v196
  v_dot2c_f32_bf16 v28, v36, v80
  v_dot2c_f32_bf16 v29, v196, v80
  v_dot2c_f32_bf16 v30, v36, v81
  v_dot2c_f32_bf16 v31, v196, v81
  v_dot2c_f32_bf16 v32, v36, v82
  v_dot2c_f32_bf16 v33, v196, v82
  v_dot2c_f32_bf16 v34, v36, v83
  v_dot2c_f32_bf16 v35, v196, v83
  s_waitcnt vmcnt(3)
  buffer_load_dwordx4 v[148:151], v7, s[28:31], s36 offen
  s_add_u32 s36, s36, 32768
  s_waitcnt vmcnt(16)
  v_lshrrev_b32 v36, 16, v197
  v_dot2c_f32_bf16 v28, v36, v84
  v_dot2c_f32_bf16 v29, v197, v84
  v_dot2c_f32_bf16 v30, v36, v85
  v_dot2c_f32_bf16 v31, v197, v85
  v_dot2c_f32_bf16 v32, v36, v86
  v_dot2c_f32_bf16 v33, v197, v86
  v_dot2c_f32_bf16 v34, v36, v87
  v_dot2c_f32_bf16 v35, v197, v87
  s_waitcnt vmcnt(3)
  buffer_load_dwordx4 v[152:155], v7, s[28:31], s36 offen
  s_add_u32 s36, s36, 32768
  s_waitcnt vmcnt(16)
  v_lshrrev_b32 v36, 16, v198
  v_dot2c_f32_bf16 v28, v36, v88
  v_dot2c_f32_bf16 v29, v198, v88
  v_dot2c_f32_bf16 v30, v36, v89
  v_dot2c_f32_bf16 v31, v198, v89
  v_dot2c_f32_bf16 v32, v36, v90
  v_dot2c_f32_bf16 v33, v198, v90
  v_dot2c_f32_bf16 v34, v36, v91
  v_dot2c_f32_bf16 v35, v198, v91
  s_waitcnt vmcnt(3)
  buffer_load_dwordx4 v[156:159], v7, s[28:31], s36 offen
  s_add_u32 s36, s36, 32768
  s_waitcnt vmcnt(16)
  v_lshrrev_b32 v36, 16, v199
  v_dot2c_f32_bf16 v28, v36, v92
  v_dot2c_f32_bf16 v29, v199, v92
  v_dot2c_f32_bf16 v30, v36, v93
  v_dot2c_f32_bf16 v31, v199, v93
  v_dot2c_f32_bf16 v32, v36, v94
  v_dot2c_f32_bf16 v33, v199, v94
  v_dot2c_f32_bf16 v34, v36, v95
  v_dot2c_f32_bf16 v35, v199, v95
  s_waitcnt vmcnt(3)
  buffer_load_dwordx4 v[160:163], v7, s[28:31], s36 offen
  s_add_u32 s36, s36, 32768
  s_waitcnt vmcnt(16)
  v_lshrrev_b32 v36, 16, v200
  v_dot2c_f32_bf16 v28, v36, v96
  v_dot2c_f32_bf16 v29, v200, v96
  v_dot2c_f32_bf16 v30, v36, v97
  v_dot2c_f32_bf16 v31, v200, v97
  v_dot2c_f32_bf16 v32, v36, v98
  v_dot2c_f32_bf16 v33, v200, v98
  v_dot2c_f32_bf16 v34, v36, v99
  v_dot2c_f32_bf16 v35, v200, v99
  s_waitcnt vmcnt(3)
  buffer_load_dwordx4 v[164:167], v7, s[28:31], s36 offen
  s_add_u32 s36, s36, 32768
  s_waitcnt vmcnt(16)
  v_lshrrev_b32 v36, 16, v201
  v_dot2c_f32_bf16 v28, v36, v100
  v_dot2c_f32_bf16 v29, v201, v100
  v_dot2c_f32_bf16 v30, v36, v101
  v_dot2c_f32_bf16 v31, v201, v101
  v_dot2c_f32_bf16 v32, v36, v102
  v_dot2c_f32_bf16 v33, v201, v102
  v_dot2c_f32_bf16 v34, v36, v103
  v_dot2c_f32_bf16 v35, v201, v103
  s_waitcnt vmcnt(3)
  buffer_load_dwordx4 v[168:171], v7, s[28:31], s36 offen
  s_add_u32 s36, s36, 32768
  s_waitcnt vmcnt(16)
  v_lshrrev_b32 v36, 16, v202
  v_dot2c_f32_bf16 v28, v36, v104
  v_dot2c_f32_bf16 v29, v202, v104
  v_dot2c_f32_bf16 v30, v36, v105
  v_dot2c_f32_bf16 v31, v202, v105
  v_dot2c_f32_bf16 v32, v36, v106
  v_dot2c_f32_bf16 v33, v202, v106
  v_dot2c_f32_bf16 v34, v36, v107
  v_dot2c_f32_bf16 v35, v202, v107
  s_waitcnt vmcnt(3)
  buffer_load_dwordx4 v[172:175], v7, s[28:31], s36 offen
  s_add_u32 s36, s36, 32768
  s_waitcnt vmcnt(16)
  v_lshrrev_b32 v36, 16, v203
  v_dot2c_f32_bf16 v28, v36, v108
  v_dot2c_f32_bf16 v29, v203, v108
  v_dot2c_f32_bf16 v30, v36, v109
  v_dot2c_f32_bf16 v31, v203, v109
  v_dot2c_f32_bf16 v32, v36, v110
  v_dot2c_f32_bf16 v33, v203, v110
  v_dot2c_f32_bf16 v34, v36, v111
  v_dot2c_f32_bf16 v35, v203, v111
  s_waitcnt vmcnt(3)
  buffer_load_dwordx4 v[176:179], v7, s[28:31], s36 offen
  s_add_u32 s36, s36, 32768
  s_waitcnt vmcnt(16)
  v_lshrrev_b32 v36, 16, v204
  v_dot2c_f32_bf16 v28, v36, v112
  v_dot2c_f32_bf16 v29, v204, v112
  v_dot2c_f32_bf16 v30, v36, v113
  v_dot2c_f32_bf16 v31, v204, v113
  v_dot2c_f32_bf16 v32, v36, v114
  v_dot2c_f32_bf16 v33, v204, v114
  v_dot2c_f32_bf16 v34, v36, v115
  v_dot2c_f32_bf16 v35, v204, v115
  s_waitcnt vmcnt(3)
  buffer_load_dwordx4 v[180:183], v7, s[28:31], s36 offen
  s_add_u32 s36, s36, 32768
  s_waitcnt vmcnt(16)
  v_lshrrev_b32 v36, 16, v205
  v_dot2c_f32_bf16 v28, v36, v116
  v_dot2c_f32_bf16 v29, v205, v116
  v_dot2c_f32_bf16 v30, v36, v117
  v_dot2c_f32_bf16 v31, v205, v117
  v_dot2c_f32_bf16 v32, v36, v118
  v_dot2c_f32_bf16 v33, v205, v118
  v_dot2c_f32_bf16 v34, v36, v119
  v_dot2c_f32_bf16 v35, v205, v119
  s_waitcnt vmcnt(3)
  buffer_load_dwordx4 v[184:187], v7, s[28:31], s36 offen
  s_add_u32 s36, s36, 32768
  s_waitcnt vmcnt(16)
  v_lshrrev_b32 v36, 16, v206
  v_dot2c_f32_bf16 v28, v36, v120
  v_dot2c_f32_bf16 v29, v206, v120
  v_dot2c_f32_bf16 v30, v36, v121
  v_dot2c_f32_bf16 v31, v206, v121
  v_dot2c_f32_bf16 v32, v36, v122
  v_dot2c_f32_bf16 v33, v206, v122
  v_dot2c_f32_bf16 v34, v36, v123
  v_dot2c_f32_bf16 v35, v206, v123
  s_waitcnt vmcnt(3)
  buffer_load_dwordx4 v[188:191], v7, s[28:31], s36 offen
  s_waitcnt vmcnt(16)
  v_lshrrev_b32 v36, 16, v207
  v_dot2c_f32_bf16 v28, v36, v124
  v_dot2c_f32_bf16 v29, v207, v124
  v_dot2c_f32_bf16 v30, v36, v125
  v_dot2c_f32_bf16 v31, v207, v125
  v_dot2c_f32_bf16 v32, v36, v126
  v_dot2c_f32_bf16 v33, v207, v126
  v_dot2c_f32_bf16 v34, v36, v127
  v_dot2c_f32_bf16 v35, v207, v127
  s_waitcnt vmcnt(15)
  v_lshrrev_b32 v36, 16, v208
  v_dot2c_f32_bf16 v28, v36, v128
  v_dot2c_f32_bf16 v29, v208, v128
  v_dot2c_f32_bf16 v30, v36, v129
  v_dot2c_f32_bf16 v31, v208, v129
  v_dot2c_f32_bf16 v32, v36, v130
  v_dot2c_f32_bf16 v33, v208, v130
  v_dot2c_f32_bf16 v34, v36, v131
  v_dot2c_f32_bf16 v35, v208, v131
  s_waitcnt vmcnt(14)
  v_lshrrev_b32 v36, 16, v209
  v_dot2c_f32_bf16 v28, v36, v132
  v_dot2c_f32_bf16 v29, v209, v132
  v_dot2c_f32_bf16 v30, v36, v133
  v_dot2c_f32_bf16 v31, v209, v133
  v_dot2c_f32_bf16 v32, v36, v134
  v_dot2c_f32_bf16 v33, v209, v134
  v_dot2c_f32_bf16 v34, v36, v135
  v_dot2c_f32_bf16 v35, v209, v135
  s_waitcnt vmcnt(13)
  v_lshrrev_b32 v36, 16, v210
  v_dot2c_f32_bf16 v28, v36, v136
  v_dot2c_f32_bf16 v29, v210, v136
  v_dot2c_f32_bf16 v30, v36, v137
  v_dot2c_f32_bf16 v31, v210, v137
  v_dot2c_f32_bf16 v32, v36, v138
  v_dot2c_f32_bf16 v33, v210, v138
  v_dot2c_f32_bf16 v34, v36, v139
  v_dot2c_f32_bf16 v35, v210, v139
  s_waitcnt vmcnt(12)
  v_lshrrev_b32 v36, 16, v211
  v_dot2c_f32_bf16 v28, v36, v140
  v_dot2c_f32_bf16 v29, v211, v140
  v_dot2c_f32_bf16 v30, v36, v141
  v_dot2c_f32_bf16 v31, v211, v141
  v_dot2c_f32_bf16 v32, v36, v142
  v_dot2c_f32_bf16 v33, v211, v142
  v_dot2c_f32_bf16 v34, v36, v143
  v_dot2c_f32_bf16 v35, v211, v143
  s_waitcnt vmcnt(11)
  v_lshrrev_b32 v36, 16, v212
  v_dot2c_f32_bf16 v28, v36, v144
  v_dot2c_f32_bf16 v29, v212, v144
  v_dot2c_f32_bf16 v30, v36, v145
  v_dot2c_f32_bf16 v31, v212, v145
  v_dot2c_f32_bf16 v32, v36, v146
  v_dot2c_f32_bf16 v33, v212, v146
  v_dot2c_f32_bf16 v34, v36, v147
  v_dot2c_f32_bf16 v35, v212, v147
  s_waitcnt vmcnt(10)
  v_lshrrev_b32 v36, 16, v213
  v_dot2c_f32_bf16 v28, v36, v148
  v_dot2c_f32_bf16 v29, v213, v148
  v_dot2c_f32_bf16 v30, v36, v149
  v_dot2c_f32_bf16 v31, v213, v149
  v_dot2c_f32_bf16 v32, v36, v150
  v_dot2c_f32_bf16 v33, v213, v150
  v_dot2c_f32_bf16 v34, v36, v151
  v_dot2c_f32_bf16 v35, v213, v151
  s_waitcnt vmcnt(9)
  v_lshrrev_b32 v36, 16, v214
  v_dot2c_f32_bf16 v28, v36, v152
  v_dot2c_f32_bf16 v29, v214, v152
  v_dot2c_f32_bf16 v30, v36, v153
  v_dot2c_f32_bf16 v31, v214, v153
  v_dot2c_f32_bf16 v32, v36, v154
  v_dot2c_f32_bf16 v33, v214, v154
  v_dot2c_f32_bf16 v34, v36, v155
  v_dot2c_f32_bf16 v35, v214, v155
  s_waitcnt vmcnt(8)
  v_lshrrev_b32 v36, 16, v215
  v_dot2c_f32_bf16 v28, v36, v156
  v_dot2c_f32_bf16 v29, v215, v156
  v_dot2c_f32_bf16 v30, v36, v157
  v_dot2c_f32_bf16 v31, v215, v157
  v_dot2c_f32_bf16 v32, v36, v158
  v_dot2c_f32_bf16 v33, v215, v158
  v_dot2c_f32_bf16 v34, v36, v159
  v_dot2c_f32_bf16 v35, v215, v159
  s_waitcnt vmcnt(7)
  v_lshrrev_b32 v36, 16, v216
  v_dot2c_f32_bf16 v28, v36, v160
  v_dot2c_f32_bf16 v29, v216, v160
  v_dot2c_f32_bf16 v30, v36, v161
  v_dot2c_f32_bf16 v31, v216, v161
  v_dot2c_f32_bf16 v32, v36, v162
  v_dot2c_f32_bf16 v33, v216, v162
  v_dot2c_f32_bf16 v34, v36, v163
  v_dot2c_f32_bf16 v35, v216, v163
  s_waitcnt vmcnt(6)
  v_lshrrev_b32 v36, 16, v217
  v_dot2c_f32_bf16 v28, v36, v164
  v_dot2c_f32_bf16 v29, v217, v164
  v_dot2c_f32_bf16 v30, v36, v165
  v_dot2c_f32_bf16 v31, v217, v165
  v_dot2c_f32_bf16 v32, v36, v166
  v_dot2c_f32_bf16 v33, v217, v166
  v_dot2c_f32_bf16 v34, v36, v167
  v_dot2c_f32_bf16 v35, v217, v167
  s_waitcnt vmcnt(5)
  v_lshrrev_b32 v36, 16, v218
  v_dot2c_f32_bf16 v28, v36, v168
  v_dot2c_f32_bf16 v29, v218, v168
  v_dot2c_f32_bf16 v30, v36, v169
  v_dot2c_f32_bf16 v31, v218, v169
  v_dot2c_f32_bf16 v32, v36, v170
  v_dot2c_f32_bf16 v33, v218, v170
  v_dot2c_f32_bf16 v34, v36, v171
  v_dot2c_f32_bf16 v35, v218, v171
  s_waitcnt vmcnt(4)
  v_lshrrev_b32 v36, 16, v219
  v_dot2c_f32_bf16 v28, v36, v172
  v_dot2c_f32_bf16 v29, v219, v172
  v_dot2c_f32_bf16 v30, v36, v173
  v_dot2c_f32_bf16 v31, v219, v173
  v_dot2c_f32_bf16 v32, v36, v174
  v_dot2c_f32_bf16 v33, v219, v174
  v_dot2c_f32_bf16 v34, v36, v175
  v_dot2c_f32_bf16 v35, v219, v175
  s_waitcnt vmcnt(3)
  v_lshrrev_b32 v36, 16, v220
  v_dot2c_f32_bf16 v28, v36, v176
  v_dot2c_f32_bf16 v29, v220, v176
  v_dot2c_f32_bf16 v30, v36, v177
  v_dot2c_f32_bf16 v31, v220, v177
  v_dot2c_f32_bf16 v32, v36, v178
  v_dot2c_f32_bf16 v33, v220, v178
  v_dot2c_f32_bf16 v34, v36, v179
  v_dot2c_f32_bf16 v35, v220, v179
  s_waitcnt vmcnt(2)
  v_lshrrev_b32 v36, 16, v221
  v_dot2c_f32_bf16 v28, v36, v180
  v_dot2c_f32_bf16 v29, v221, v180
  v_dot2c_f32_bf16 v30, v36, v181
  v_dot2c_f32_bf16 v31, v221, v181
  v_dot2c_f32_bf16 v32, v36, v182
  v_dot2c_f32_bf16 v33, v221, v182
  v_dot2c_f32_bf16 v34, v36, v183
  v_dot2c_f32_bf16 v35, v221, v183
  s_waitcnt vmcnt(1)
  v_lshrrev_b32 v36, 16, v222
  v_dot2c_f32_bf16 v28, v36, v184
  v_dot2c_f32_bf16 v29, v222, v184
  v_dot2c_f32_bf16 v30, v36, v185
  v_dot2c_f32_bf16 v31, v222, v185
  v_dot2c_f32_bf16 v32, v36, v186
  v_dot2c_f32_bf16 v33, v222, v186
  v_dot2c_f32_bf16 v34, v36, v187
  v_dot2c_f32_bf16 v35, v222, v187
  s_waitcnt vmcnt(0)
  v_lshrrev_b32 v36, 16, v223
  v_dot2c_f32_bf16 v28, v36, v188
  v_dot2c_f32_bf16 v29, v223, v188
  v_dot2c_f32_bf16 v30, v36, v189
  v_dot2c_f32_bf16 v31, v223, v189
  v_dot2c_f32_bf16 v32, v36, v190
  v_dot2c_f32_bf16 v33, v223, v190
  v_dot2c_f32_bf16 v34, v36, v191
  v_dot2c_f32_bf16 v35, v223, v191
  v_permlane32_swap_b32 v28, v32
  v_permlane32_swap_b32 v29, v33
  v_permlane32_swap_b32 v30, v34
  v_permlane32_swap_b32 v31, v35
  v_add_f32 v28, v28, v32
  v_add_f32 v29, v29, v33
  v_add_f32 v30, v30, v34
  v_add_f32 v31, v31, v35
  s_nop 0
  v_permlane16_swap_b32 v28, v30
  v_permlane16_swap_b32 v29, v31
  v_add_f32 v28, v28, v30
  v_add_f32 v29, v29, v31
  v_lshlrev_b32 v6, 5, v4
  v_lshl_add_u32 v6, v3, 3, v6
  s_lshl_b32 s48, s3, 9
  v_add_u32 v6, s48, v6
  ds_write_b64 v6, v[28:29] offset:11264
  s_waitcnt lgkmcnt(0)
  s_mov_b64 exec, 1
  ds_add_u32 v60, v61 offset:4
  s_mov_b64 exec, -1
H_sync2:
  ds_read_b32 v62, v60 offset:4
  s_waitcnt lgkmcnt(0)
  v_readfirstlane_b32 s48, v62
  s_nop 1
  s_cmp_lt_u32 s48, 4
  s_cbranch_scc1 H_sync2
  s_cmp_lg_u32 s3, 0
  s_cbranch_scc1 A_qdone
  v_lshlrev_b32 v6, 3, v1
  ds_read_b64 v[36:37], v6 offset:11264
  ds_read_b64 v[38:39], v6 offset:11776
  ds_read_b64 v[40:41], v6 offset:12288
  ds_read_b64 v[42:43], v6 offset:12800
  s_waitcnt lgkmcnt(0)
  v_add_f32 v36, v36, v38
  v_add_f32 v37, v37, v39
  v_add_f32 v40, v40, v42
  v_add_f32 v41, v41, v43
  v_add_f32 v36, v36, v40
  v_add_f32 v37, v37, v41
  v_cvt_pk_bf16_f32 v36, v36, v37
  v_lshlrev_b32 v6, 2, v1
  ds_write_b32 v6, v36 offset:256
  s_waitcnt lgkmcnt(0)
A_qdone:
  s_barrier
  s_cmp_lt_u32 s43, 42
  s_cbranch_scc1 A_noffn
  s_and_b32 s44, s43, 7
  s_lshr_b32 s45, s43, 3
  s_cmp_lt_u32 s44, 2
  s_cselect_b32 s48, 6, 5
  s_sub_u32 s45, s45, s48
  s_lshl_b32 s45, s45, 1
  s_add_u32 s45, s45, s42
  s_mul_i32 s49, s44, 22
  s_lshl_b32 s48, s44, 1
  s_min_u32 s48, s48, 4
  s_sub_u32 s49, s49, s48
  s_add_u32 s49, s49, s45
  s_and_b32 s44, s49, 3
  s_mul_i32 s44, s44, 1
  s_add_u32 s44, s44, 3
H_prog3:
  ds_read_b32 v62, v60 offset:32
  s_waitcnt lgkmcnt(0)
  v_readfirstlane_b32 s48, v62
  s_nop 1
  s_cmp_ge_u32 s48, s44
  s_cbranch_scc1 H_prog3_ok
  s_sleep 16
  s_branch H_prog3
H_prog3_ok:
A_f1:
  s_lshr_b32 s54, s49, 2
  s_and_b32 s55, s49, 3
  s_lshl_b32 s55, s55, 7
  s_lshl_b32 s44, s3, 5
  s_add_u32 s55, s55, s44
  s_mul_i32 s44, s55, 2752
  s_lshl_b32 s45, s54, 6
  s_add_u32 s44, s44, s45
  s_add_u32 s28, s16, s44
  s_addc_u32 s29, s17, 0
  s_mov_b32 s30, 88064
  s_mov_b32 s31, 0x20000
  s_add_u32 s32, s18, s44
  s_addc_u32 s33, s19, 0
  s_mov_b32 s34, 88064
  s_mov_b32 s35, 0x20000
  v_lshrrev_b32 v6, 2, v1
  s_mov_b32 s45, 2752
  v_mul_lo_u32 v7, s45, v6
  v_and_b32 v36, 3, v1
  v_lshl_add_u32 v7, v36, 4, v7
  s_mov_b32 s36, 44032
  buffer_load_dwordx4 v[64:67], v7, s[28:31], 0 offen
  buffer_load_dwordx4 v[72:75], v7, s[32:35], 0 offen
  buffer_load_dwordx4 v[68:71], v7, s[28:31], s36 offen
  buffer_load_dwordx4 v[76:79], v7, s[32:35], s36 offen
  v_add_u32 v6, s55, v6
  v_lshlrev_b32 v6, 2, v6
  ds_read_b32 v80, v6 offset:3072
  ds_read_b32 v81, v6 offset:3136
  ds_read_b32 v82, v6 offset:5120
  ds_read_b32 v83, v6 offset:5184
  ds_read_b32 v84, v6 offset:7168
  ds_read_b32 v85, v6 offset:7232
  ds_read_b32 v86, v6 offset:9216
  ds_read_b32 v87, v6 offset:9280
  v_mov_b32 v128, 0
  v_mov_b32 v129, 0
  v_mov_b32 v130, 0
  v_mov_b32 v131, 0
  v_mov_b32 v132, 0
  v_mov_b32 v133, 0
  v_mov_b32 v134, 0
  v_mov_b32 v135, 0
  v_mov_b32 v136, 0
  v_mov_b32 v137, 0
  v_mov_b32 v138, 0
  v_mov_b32 v139, 0
  v_mov_b32 v140, 0
  v_mov_b32 v141, 0
  v_mov_b32 v142, 0
  v_mov_b32 v143, 0
  v_mov_b32 v144, 0
  v_mov_b32 v145, 0
  v_mov_b32 v146, 0
  v_mov_b32 v147, 0
  v_mov_b32 v148, 0
  v_mov_b32 v149, 0
  v_mov_b32 v150, 0
  v_mov_b32 v151, 0
  v_mov_b32 v152, 0
  v_mov_b32 v153, 0
  v_mov_b32 v154, 0
  v_mov_b32 v155, 0
  v_mov_b32 v156, 0
  v_mov_b32 v157, 0
  v_mov_b32 v158, 0
  v_mov_b32 v159, 0
  v_mov_b32 v160, 0
  v_mov_b32 v161, 0
  v_mov_b32 v162, 0
  v_mov_b32 v163, 0
  v_mov_b32 v164, 0
  v_mov_b32 v165, 0
  v_mov_b32 v166, 0
  v_mov_b32 v167, 0
  v_mov_b32 v168, 0
  v_mov_b32 v169, 0
  v_mov_b32 v170, 0
  v_mov_b32 v171, 0
  v_mov_b32 v172, 0
  v_mov_b32 v173, 0
  v_mov_b32 v174, 0
  v_mov_b32 v175, 0
  v_mov_b32 v176, 0
  v_mov_b32 v177, 0
  v_mov_b32 v178, 0
  v_mov_b32 v179, 0
  v_mov_b32 v180, 0
  v_mov_b32 v181, 0
  v_mov_b32 v182, 0
  v_mov_b32 v183, 0
  v_mov_b32 v184, 0
  v_mov_b32 v185, 0
  v_mov_b32 v186, 0
  v_mov_b32 v187, 0
  v_mov_b32 v188, 0
  v_mov_b32 v189, 0
  v_mov_b32 v190, 0
  v_mov_b32 v191, 0
  s_waitcnt lgkmcnt(0)
  s_waitcnt vmcnt(2)
  v_lshrrev_b32 v36, 16, v80
  v_dot2c_f32_bf16 v128, v36, v64
  v_dot2c_f32_bf16 v129, v80, v64
  v_dot2c_f32_bf16 v130, v36, v65
  v_dot2c_f32_bf16 v131, v80, v65
  v_dot2c_f32_bf16 v132, v36, v66
  v_dot2c_f32_bf16 v133, v80, v66
  v_dot2c_f32_bf16 v134, v36, v67
  v_dot2c_f32_bf16 v135, v80, v67
  v_dot2c_f32_bf16 v160, v36, v72
  v_dot2c_f32_bf16 v161, v80, v72
  v_dot2c_f32_bf16 v162, v36, v73
  v_dot2c_f32_bf16 v163, v80, v73
  v_dot2c_f32_bf16 v164, v36, v74
  v_dot2c_f32_bf16 v165, v80, v74
  v_dot2c_f32_bf16 v166, v36, v75
  v_dot2c_f32_bf16 v167, v80, v75
  v_lshrrev_b32 v36, 16, v82
  v_dot2c_f32_bf16 v136, v36, v64
  v_dot2c_f32_bf16 v137, v82, v64
  v_dot2c_f32_bf16 v138, v36, v65
  v_dot2c_f32_bf16 v139, v82, v65
  v_dot2c_f32_bf16 v140, v36, v66
  v_dot2c_f32_bf16 v141, v82, v66
  v_dot2c_f32_bf16 v142, v36, v67
  v_dot2c_f32_bf16 v143, v82, v67
  v_dot2c_f32_bf16 v168, v36, v72
  v_dot2c_f32_bf16 v169, v82, v72
  v_dot2c_f32_bf16 v170, v36, v73
  v_dot2c_f32_bf16 v171, v82, v73
  v_dot2c_f32_bf16 v172, v36, v74
  v_dot2c_f32_bf16 v173, v82, v74
  v_dot2c_f32_bf16 v174, v36, v75
  v_dot2c_f32_bf16 v175, v82, v75
  v_lshrrev_b32 v36, 16, v84
  v_dot2c_f32_bf16 v144, v36, v64
  v_dot2c_f32_bf16 v145, v84, v64
  v_dot2c_f32_bf16 v146, v36, v65
  v_dot2c_f32_bf16 v147, v84, v65
  v_dot2c_f32_bf16 v148, v36, v66
  v_dot2c_f32_bf16 v149, v84, v66
  v_dot2c_f32_bf16 v150, v36, v67
  v_dot2c_f32_bf16 v151, v84, v67
  v_dot2c_f32_bf16 v176, v36, v72
  v_dot2c_f32_bf16 v177, v84, v72
  v_dot2c_f32_bf16 v178, v36, v73
  v_dot2c_f32_bf16 v179, v84, v73
  v_dot2c_f32_bf16 v180, v36, v74
  v_dot2c_f32_bf16 v181, v84, v74
  v_dot2c_f32_bf16 v182, v36, v75
  v_dot2c_f32_bf16 v183, v84, v75
  v_lshrrev_b32 v36, 16, v86
  v_dot2c_f32_bf16 v152, v36, v64
  v_dot2c_f32_bf16 v153, v86, v64
  v_dot2c_f32_bf16 v154, v36, v65
  v_dot2c_f32_bf16 v155, v86, v65
  v_dot2c_f32_bf16 v156, v36, v66
  v_dot2c_f32_bf16 v157, v86, v66
  v_dot2c_f32_bf16 v158, v36, v67
  v_dot2c_f32_bf16 v159, v86, v67
  v_dot2c_f32_bf16 v184, v36, v72
  v_dot2c_f32_bf16 v185, v86, v72
  v_dot2c_f32_bf16 v186, v36, v73
  v_dot2c_f32_bf16 v187, v86, v73
  v_dot2c_f32_bf16 v188, v36, v74
  v_dot2c_f32_bf16 v189, v86, v74
  v_dot2c_f32_bf16 v190, v36, v75
  v_dot2c_f32_bf16 v191, v86, v75
  s_waitcnt vmcnt(0)
  v_lshrrev_b32 v36, 16, v81
  v_dot2c_f32_bf16 v128, v36, v68
  v_dot2c_f32_bf16 v129, v81, v68
  v_dot2c_f32_bf16 v130, v36, v69
  v_dot2c_f32_bf16 v131, v81, v69
  v_dot2c_f32_bf16 v132, v36, v70
  v_dot2c_f32_bf16 v133, v81, v70
  v_dot2c_f32_bf16 v134, v36, v71
  v_dot2c_f32_bf16 v135, v81, v71
  v_dot2c_f32_bf16 v160, v36, v76
  v_dot2c_f32_bf16 v161, v81, v76
  v_dot2c_f32_bf16 v162, v36, v77
  v_dot2c_f32_bf16 v163, v81, v77
  v_dot2c_f32_bf16 v164, v36, v78
  v_dot2c_f32_bf16 v165, v81, v78
  v_dot2c_f32_bf16 v166, v36, v79
  v_dot2c_f32_bf16 v167, v81, v79
  v_lshrrev_b32 v36, 16, v83
  v_dot2c_f32_bf16 v136, v36, v68
  v_dot2c_f32_bf16 v137, v83, v68
  v_dot2c_f32_bf16 v138, v36, v69
  v_dot2c_f32_bf16 v139, v83, v69
  v_dot2c_f32_bf16 v140, v36, v70
  v_dot2c_f32_bf16 v141, v83, v70
  v_dot2c_f32_bf16 v142, v36, v71
  v_dot2c_f32_bf16 v143, v83, v71
  v_dot2c_f32_bf16 v168, v36, v76
  v_dot2c_f32_bf16 v169, v83, v76
  v_dot2c_f32_bf16 v170, v36, v77
  v_dot2c_f32_bf16 v171, v83, v77
  v_dot2c_f32_bf16 v172, v36, v78
  v_dot2c_f32_bf16 v173, v83, v78
  v_dot2c_f32_bf16 v174, v36, v79
  v_dot2c_f32_bf16 v175, v83, v79
  v_lshrrev_b32 v36, 16, v85
  v_dot2c_f32_bf16 v144, v36, v68
  v_dot2c_f32_bf16 v145, v85, v68
  v_dot2c_f32_bf16 v146, v36, v69
  v_dot2c_f32_bf16 v147, v85, v69
  v_dot2c_f32_bf16 v148, v36, v70
  v_dot2c_f32_bf16 v149, v85, v70
  v_dot2c_f32_bf16 v150, v36, v71
  v_dot2c_f32_bf16 v151, v85, v71
  v_dot2c_f32_bf16 v176, v36, v76
  v_dot2c_f32_bf16 v177, v85, v76
  v_dot2c_f32_bf16 v178, v36, v77
  v_dot2c_f32_bf16 v179, v85, v77
  v_dot2c_f32_bf16 v180, v36, v78
  v_dot2c_f32_bf16 v181, v85, v78
  v_dot2c_f32_bf16 v182, v36, v79
  v_dot2c_f32_bf16 v183, v85, v79
  v_lshrrev_b32 v36, 16, v87
  v_dot2c_f32_bf16 v152, v36, v68
  v_dot2c_f32_bf16 v153, v87, v68
  v_dot2c_f32_bf16 v154, v36, v69
  v_dot2c_f32_bf16 v155, v87, v69
  v_dot2c_f32_bf16 v156, v36, v70
  v_dot2c_f32_bf16 v157, v87, v70
  v_dot2c_f32_bf16 v158, v36, v71
  v_dot2c_f32_bf16 v159, v87, v71
  v_dot2c_f32_bf16 v184, v36, v76
  v_dot2c_f32_bf16 v185, v87, v76
  v_dot2c_f32_bf16 v186, v36, v77
  v_dot2c_f32_bf16 v187, v87, v77
  v_dot2c_f32_bf16 v188, v36, v78
  v_dot2c_f32_bf16 v189, v87, v78
  v_dot2c_f32_bf16 v190, v36, v79
  v_dot2c_f32_bf16 v191, v87, v79
  v_permlane32_swap_b32 v128, v144
  v_permlane32_swap_b32 v129, v145
  v_permlane32_swap_b32 v130, v146
  v_permlane32_swap_b32 v131, v147
  v_permlane32_swap_b32 v132, v148
  v_permlane32_swap_b32 v133, v149
  v_permlane32_swap_b32 v134, v150
  v_permlane32_swap_b32 v135, v151
  v_permlane32_swap_b32 v136, v152
  v_permlane32_swap_b32 v137, v153
  v_permlane32_swap_b32 v138, v154
  v_permlane32_swap_b32 v139, v155
  v_permlane32_swap_b32 v140, v156
  v_permlane32_swap_b32 v141, v157
  v_permlane32_swap_b32 v142, v158
  v_permlane32_swap_b32 v143, v159
  v_add_f32 v128, v128, v144
  v_add_f32 v129, v129, v145
  v_add_f32 v130, v130, v146
  v_add_f32 v131, v131, v147
  v_add_f32 v132, v132, v148
  v_add_f32 v133, v133, v149
  v_add_f32 v134, v134, v150
  v_add_f32 v135, v135, v151
  v_add_f32 v136, v136, v152
  v_add_f32 v137, v137, v153
  v_add_f32 v138, v138, v154
  v_add_f32 v139, v139, v155
  v_add_f32 v140, v140, v156
  v_add_f32 v141, v141, v157
  v_add_f32 v142, v142, v158
  v_add_f32 v143, v143, v159
  v_permlane16_swap_b32 v128, v136
  v_permlane16_swap_b32 v129, v137
  v_permlane16_swap_b32 v130, v138
  v_permlane16_swap_b32 v131, v139
  v_permlane16_swap_b32 v132, v140
  v_permlane16_swap_b32 v133, v141
  v_permlane16_swap_b32 v134, v142
  v_permlane16_swap_b32 v135, v143
  v_add_f32 v128, v128, v136
  v_add_f32 v129, v129, v137
  v_add_f32 v130, v130, v138
  v_add_f32 v131, v131, v139
  v_add_f32 v132, v132, v140
  v_add_f32 v133, v133, v141
  v_add_f32 v134, v134, v142
  v_add_f32 v135, v135, v143
  v_add_f32_dpp v128, v128, v128 row_ror:8 row_mask:0xf bank_mask:0x3
  v_add_f32_dpp v129, v129, v129 row_ror:8 row_mask:0xf bank_mask:0x3
  v_add_f32_dpp v130, v130, v130 row_ror:8 row_mask:0xf bank_mask:0x3
  v_add_f32_dpp v131, v131, v131 row_ror:8 row_mask:0xf bank_mask:0x3
  v_add_f32_dpp v128, v132, v132 row_ror:8 row_mask:0xf bank_mask:0xc
  v_add_f32_dpp v129, v133, v133 row_ror:8 row_mask:0xf bank_mask:0xc
  v_add_f32_dpp v130, v134, v134 row_ror:8 row_mask:0xf bank_mask:0xc
  v_add_f32_dpp v131, v135, v135 row_ror:8 row_mask:0xf bank_mask:0xc
  v_add_f32_dpp v128, v128, v128 row_ror:12 row_mask:0xf bank_mask:0x5
  v_add_f32_dpp v129, v129, v129 row_ror:12 row_mask:0xf bank_mask:0x5
  s_nop 0
  v_add_f32_dpp v128, v130, v130 row_ror:4 row_mask:0xf bank_mask:0xa
  v_add_f32_dpp v129, v131, v131 row_ror:4 row_mask:0xf bank_mask:0xa
  v_permlane32_swap_b32 v160, v176
  v_permlane32_swap_b32 v161, v177
  v_permlane32_swap_b32 v162, v178
  v_permlane32_swap_b32 v163, v179
  v_permlane32_swap_b32 v164, v180
  v_permlane32_swap_b32 v165, v181
  v_permlane32_swap_b32 v166, v182
  v_permlane32_swap_b32 v167, v183
  v_permlane32_swap_b32 v168, v184
  v_permlane32_swap_b32 v169, v185
  v_permlane32_swap_b32 v170, v186
  v_permlane32_swap_b32 v171, v187
  v_permlane32_swap_b32 v172, v188
  v_permlane32_swap_b32 v173, v189
  v_permlane32_swap_b32 v174, v190
  v_permlane32_swap_b32 v175, v191
  v_add_f32 v160, v160, v176
  v_add_f32 v161, v161, v177
  v_add_f32 v162, v162, v178
  v_add_f32 v163, v163, v179
  v_add_f32 v164, v164, v180
  v_add_f32 v165, v165, v181
  v_add_f32 v166, v166, v182
  v_add_f32 v167, v167, v183
  v_add_f32 v168, v168, v184
  v_add_f32 v169, v169, v185
  v_add_f32 v170, v170, v186
  v_add_f32 v171, v171, v187
  v_add_f32 v172, v172, v188
  v_add_f32 v173, v173, v189
  v_add_f32 v174, v174, v190
  v_add_f32 v175, v175, v191
  v_permlane16_swap_b32 v160, v168
  v_permlane16_swap_b32 v161, v169
  v_permlane16_swap_b32 v162, v170
  v_permlane16_swap_b32 v163, v171
  v_permlane16_swap_b32 v164, v172
  v_permlane16_swap_b32 v165, v173
  v_permlane16_swap_b32 v166, v174
  v_permlane16_swap_b32 v167, v175
  v_add_f32 v160, v160, v168
  v_add_f32 v161, v161, v169
  v_add_f32 v162, v162, v170
  v_add_f32 v163, v163, v171
  v_add_f32 v164, v164, v172
  v_add_f32 v165, v165, v173
  v_add_f32 v166, v166, v174
  v_add_f32 v167, v167, v175
  v_add_f32_dpp v160, v160, v160 row_ror:8 row_mask:0xf bank_mask:0x3
  v_add_f32_dpp v161, v161, v161 row_ror:8 row_mask:0xf bank_mask:0x3
  v_add_f32_dpp v162, v162, v162 row_ror:8 row_mask:0xf bank_mask:0x3
  v_add_f32_dpp v163, v163, v163 row_ror:8 row_mask:0xf bank_mask:0x3
  v_add_f32_dpp v160, v164, v164 row_ror:8 row_mask:0xf bank_mask:0xc
  v_add_f32_dpp v161, v165, v165 row_ror:8 row_mask:0xf bank_mask:0xc
  v_add_f32_dpp v162, v166, v166 row_ror:8 row_mask:0xf bank_mask:0xc
  v_add_f32_dpp v163, v167, v167 row_ror:8 row_mask:0xf bank_mask:0xc
  v_add_f32_dpp v160, v160, v160 row_ror:12 row_mask:0xf bank_mask:0x5
  v_add_f32_dpp v161, v161, v161 row_ror:12 row_mask:0xf bank_mask:0x5
  s_nop 0
  v_add_f32_dpp v160, v162, v162 row_ror:4 row_mask:0xf bank_mask:0xa
  v_add_f32_dpp v161, v163, v163 row_ror:4 row_mask:0xf bank_mask:0xa
  v_mov_b32 v36, v128
  v_mov_b32 v37, v129
  v_mov_b32 v38, v160
  v_mov_b32 v39, v161
  s_lshl_b32 s44, s3, 10
  v_add_u32 v6, s44, v5
  ds_write_b128 v6, v[36:39] offset:19456
  s_waitcnt lgkmcnt(0)
  s_mov_b64 exec, 1
  ds_add_u32 v60, v61 offset:12
  s_mov_b64 exec, -1
H_sync4:
  ds_read_b32 v62, v60 offset:12
  s_waitcnt lgkmcnt(0)
  v_readfirstlane_b32 s48, v62
  s_nop 1
  s_cmp_lt_u32 s48, 4
  s_cbranch_scc1 H_sync4
  s_cmp_lg_u32 s3, 0
  s_cbranch_scc1 F1_done
  ds_read_b128 v[36:39], v5 offset:19456
  ds_read_b128 v[40:43], v5 offset:20480
  ds_read_b128 v[44:47], v5 offset:21504
  ds_read_b128 v[48:51], v5 offset:22528
  s_lshl_b32 s44, s49, 10
  s_add_u32 s44, s44, 1572864
  v_add_u32 v6, s44, v5
  s_waitcnt lgkmcnt(0)
  v_add_f32 v36, v36, v40
  v_add_f32 v44, v44, v48
  v_add_f32 v37, v37, v41
  v_add_f32 v45, v45, v49
  v_add_f32 v38, v38, v42
  v_add_f32 v46, v46, v50
  v_add_f32 v39, v39, v43
  v_add_f32 v47, v47, v51
  v_add_f32 v36, v36, v44
  v_add_f32 v37, v37, v45
  v_add_f32 v38, v38, v46
  v_add_f32 v39, v39, v47
  global_store_dwordx4 v6, v[36:39], s[26:27] sc1
  s_waitcnt vmcnt(0)
  s_nop 0
  v_mov_b32 v6, 128
  s_mov_b64 exec, 1
  global_atomic_add v6, v61, s[24:25]
  s_mov_b64 exec, -1
F1_done:
A_noffn:
  s_lshl_b32 s48, s40, 7
  s_lshl_b32 s44, s3, 5
  s_add_u32 s48, s48, s44
  s_lshl_b32 s48, s48, 10
  s_add_u32 s32, s12, s48
  s_addc_u32 s33, s13, 0
  s_mov_b32 s34, 0x8000
  s_mov_b32 s35, 0x20000
  s_mov_b32 s36, 0
  buffer_load_dwordx4 v[64:67], v5, s[32:35], s36 offen offset:0
  buffer_load_dwordx4 v[68:71], v5, s[32:35], s36 offen offset:1024
  s_waitcnt vmcnt(1)
  buffer_load_dwordx4 v[72:75], v5, s[32:35], s36 offen offset:2048
  s_waitcnt vmcnt(1)
  buffer_load_dwordx4 v[76:79], v5, s[32:35], s36 offen offset:3072
  s_add_u32 s36, s36, 4096
  s_waitcnt vmcnt(1)
  buffer_load_dwordx4 v[80:83], v5, s[32:35], s36 offen offset:0
  s_waitcnt vmcnt(1)
  buffer_load_dwordx4 v[84:87], v5, s[32:35], s36 offen offset:1024
  s_waitcnt vmcnt(1)
  buffer_load_dwordx4 v[88:91], v5, s[32:35], s36 offen offset:2048
  s_waitcnt vmcnt(1)
  buffer_load_dwordx4 v[92:95], v5, s[32:35], s36 offen offset:3072
  s_add_u32 s36, s36, 4096
  s_waitcnt vmcnt(1)
  buffer_load_dwordx4 v[96:99], v5, s[32:35], s36 offen offset:0
  s_waitcnt vmcnt(1)
  buffer_load_dwordx4 v[100:103], v5, s[32:35], s36 offen offset:1024
  s_waitcnt vmcnt(1)
  buffer_load_dwordx4 v[104:107], v5, s[32:35], s36 offen offset:2048
  s_waitcnt vmcnt(1)
  buffer_load_dwordx4 v[108:111], v5, s[32:35], s36 offen offset:3072
  s_add_u32 s36, s36, 4096
  s_waitcnt vmcnt(1)
  buffer_load_dwordx4 v[112:115], v5, s[32:35], s36 offen offset:0
  s_waitcnt vmcnt(1)
  buffer_load_dwordx4 v[116:119], v5, s[32:35], s36 offen offset:1024
  s_waitcnt vmcnt(1)
  buffer_load_dwordx4 v[120:123], v5, s[32:35], s36 offen offset:2048
  s_waitcnt vmcnt(1)
  buffer_load_dwordx4 v[124:127], v5, s[32:35], s36 offen offset:3072
  s_add_u32 s36, s36, 4096
  s_waitcnt vmcnt(1)
  buffer_load_dwordx4 v[128:131], v5, s[32:35], s36 offen offset:0
  s_waitcnt vmcnt(1)
  buffer_load_dwordx4 v[132:135], v5, s[32:35], s36 offen offset:1024
  s_waitcnt vmcnt(1)
  buffer_load_dwordx4 v[136:139], v5, s[32:35], s36 offen offset:2048
  s_waitcnt vmcnt(1)
  buffer_load_dwordx4 v[140:143], v5, s[32:35], s36 offen offset:3072
  s_add_u32 s36, s36, 4096
  s_waitcnt vmcnt(1)
  buffer_load_dwordx4 v[144:147], v5, s[32:35], s36 offen offset:0
  s_waitcnt vmcnt(1)
  buffer_load_dwordx4 v[148:151], v5, s[32:35], s36 offen offset:1024
  s_waitcnt vmcnt(1)
  buffer_load_dwordx4 v[152:155], v5, s[32:35], s36 offen offset:2048
  s_waitcnt vmcnt(1)
  buffer_load_dwordx4 v[156:159], v5, s[32:35], s36 offen offset:3072
  s_add_u32 s36, s36, 4096
  s_waitcnt vmcnt(1)
  buffer_load_dwordx4 v[160:163], v5, s[32:35], s36 offen offset:0
  s_waitcnt vmcnt(1)
  buffer_load_dwordx4 v[164:167], v5, s[32:35], s36 offen offset:1024
  s_waitcnt vmcnt(1)
  buffer_load_dwordx4 v[168:171], v5, s[32:35], s36 offen offset:2048
  s_waitcnt vmcnt(1)
  buffer_load_dwordx4 v[172:175], v5, s[32:35], s36 offen offset:3072
  s_add_u32 s36, s36, 4096
  s_waitcnt vmcnt(1)
  buffer_load_dwordx4 v[176:179], v5, s[32:35], s36 offen offset:0
  s_waitcnt vmcnt(1)
  buffer_load_dwordx4 v[180:183], v5, s[32:35], s36 offen offset:1024
  s_waitcnt vmcnt(1)
  buffer_load_dwordx4 v[184:187], v5, s[32:35], s36 offen offset:2048
  s_waitcnt vmcnt(1)
  buffer_load_dwordx4 v[188:191], v5, s[32:35], s36 offen offset:3072
  s_waitcnt vmcnt(1)
  s_waitcnt vmcnt(0)
  s_mov_b32 s44, 0x05040100
  s_mov_b32 s45, 0x07060302
  v_perm_b32 v36, v68, v64, s44
  v_perm_b32 v68, v68, v64, s45
  v_mov_b32 v64, v36
  v_perm_b32 v36, v69, v65, s44
  v_perm_b32 v69, v69, v65, s45
  v_mov_b32 v65, v36
  v_perm_b32 v36, v70, v66, s44
  v_perm_b32 v70, v70, v66, s45
  v_mov_b32 v66, v36
  v_perm_b32 v36, v71, v67, s44
  v_perm_b32 v71, v71, v67, s45
  v_mov_b32 v67, v36
  v_perm_b32 v36, v76, v72, s44
  v_perm_b32 v76, v76, v72, s45
  v_mov_b32 v72, v36
  v_perm_b32 v36, v77, v73, s44
  v_perm_b32 v77, v77, v73, s45
  v_mov_b32 v73, v36
  v_perm_b32 v36, v78, v74, s44
  v_perm_b32 v78, v78, v74, s45
  v_mov_b32 v74, v36
  v_perm_b32 v36, v79, v75, s44
  v_perm_b32 v79, v79, v75, s45
  v_mov_b32 v75, v36
  v_perm_b32 v36, v84, v80, s44
  v_perm_b32 v84, v84, v80, s45
  v_mov_b32 v80, v36
  v_perm_b32 v36, v85, v81, s44
  v_perm_b32 v85, v85, v81, s45
  v_mov_b32 v81, v36
  v_perm_b32 v36, v86, v82, s44
  v_perm_b32 v86, v86, v82, s45
  v_mov_b32 v82, v36
  v_perm_b32 v36, v87, v83, s44
  v_perm_b32 v87, v87, v83, s45
  v_mov_b32 v83, v36
  v_perm_b32 v36, v92, v88, s44
  v_perm_b32 v92, v92, v88, s45
  v_mov_b32 v88, v36
  v_perm_b32 v36, v93, v89, s44
  v_perm_b32 v93, v93, v89, s45
  v_mov_b32 v89, v36
  v_perm_b32 v36, v94, v90, s44
  v_perm_b32 v94, v94, v90, s45
  v_mov_b32 v90, v36
  v_perm_b32 v36, v95, v91, s44
  v_perm_b32 v95, v95, v91, s45
  v_mov_b32 v91, v36
  v_perm_b32 v36, v100, v96, s44
  v_perm_b32 v100, v100, v96, s45
  v_mov_b32 v96, v36
  v_perm_b32 v36, v101, v97, s44
  v_perm_b32 v101, v101, v97, s45
  v_mov_b32 v97, v36
  v_perm_b32 v36, v102, v98, s44
  v_perm_b32 v102, v102, v98, s45
  v_mov_b32 v98, v36
  v_perm_b32 v36, v103, v99, s44
  v_perm_b32 v103, v103, v99, s45
  v_mov_b32 v99, v36
  v_perm_b32 v36, v108, v104, s44
  v_perm_b32 v108, v108, v104, s45
  v_mov_b32 v104, v36
  v_perm_b32 v36, v109, v105, s44
  v_perm_b32 v109, v109, v105, s45
  v_mov_b32 v105, v36
  v_perm_b32 v36, v110, v106, s44
  v_perm_b32 v110, v110, v106, s45
  v_mov_b32 v106, v36
  v_perm_b32 v36, v111, v107, s44
  v_perm_b32 v111, v111, v107, s45
  v_mov_b32 v107, v36
  v_perm_b32 v36, v116, v112, s44
  v_perm_b32 v116, v116, v112, s45
  v_mov_b32 v112, v36
  v_perm_b32 v36, v117, v113, s44
  v_perm_b32 v117, v117, v113, s45
  v_mov_b32 v113, v36
  v_perm_b32 v36, v118, v114, s44
  v_perm_b32 v118, v118, v114, s45
  v_mov_b32 v114, v36
  v_perm_b32 v36, v119, v115, s44
  v_perm_b32 v119, v119, v115, s45
  v_mov_b32 v115, v36
  v_perm_b32 v36, v124, v120, s44
  v_perm_b32 v124, v124, v120, s45
  v_mov_b32 v120, v36
  v_perm_b32 v36, v125, v121, s44
  v_perm_b32 v125, v125, v121, s45
  v_mov_b32 v121, v36
  v_perm_b32 v36, v126, v122, s44
  v_perm_b32 v126, v126, v122, s45
  v_mov_b32 v122, v36
  v_perm_b32 v36, v127, v123, s44
  v_perm_b32 v127, v127, v123, s45
  v_mov_b32 v123, v36
  v_perm_b32 v36, v132, v128, s44
  v_perm_b32 v132, v132, v128, s45
  v_mov_b32 v128, v36
  v_perm_b32 v36, v133, v129, s44
  v_perm_b32 v133, v133, v129, s45
  v_mov_b32 v129, v36
  v_perm_b32 v36, v134, v130, s44
  v_perm_b32 v134, v134, v130, s45
  v_mov_b32 v130, v36
  v_perm_b32 v36, v135, v131, s44
  v_perm_b32 v135, v135, v131, s45
  v_mov_b32 v131, v36
  v_perm_b32 v36, v140, v136, s44
  v_perm_b32 v140, v140, v136, s45
  v_mov_b32 v136, v36
  v_perm_b32 v36, v141, v137, s44
  v_perm_b32 v141, v141, v137, s45
  v_mov_b32 v137, v36
  v_perm_b32 v36, v142, v138, s44
  v_perm_b32 v142, v142, v138, s45
  v_mov_b32 v138, v36
  v_perm_b32 v36, v143, v139, s44
  v_perm_b32 v143, v143, v139, s45
  v_mov_b32 v139, v36
  v_perm_b32 v36, v148, v144, s44
  v_perm_b32 v148, v148, v144, s45
  v_mov_b32 v144, v36
  v_perm_b32 v36, v149, v145, s44
  v_perm_b32 v149, v149, v145, s45
  v_mov_b32 v145, v36
  v_perm_b32 v36, v150, v146, s44
  v_perm_b32 v150, v150, v146, s45
  v_mov_b32 v146, v36
  v_perm_b32 v36, v151, v147, s44
  v_perm_b32 v151, v151, v147, s45
  v_mov_b32 v147, v36
  v_perm_b32 v36, v156, v152, s44
  v_perm_b32 v156, v156, v152, s45
  v_mov_b32 v152, v36
  v_perm_b32 v36, v157, v153, s44
  v_perm_b32 v157, v157, v153, s45
  v_mov_b32 v153, v36
  v_perm_b32 v36, v158, v154, s44
  v_perm_b32 v158, v158, v154, s45
  v_mov_b32 v154, v36
  v_perm_b32 v36, v159, v155, s44
  v_perm_b32 v159, v159, v155, s45
  v_mov_b32 v155, v36
  v_perm_b32 v36, v164, v160, s44
  v_perm_b32 v164, v164, v160, s45
  v_mov_b32 v160, v36
  v_perm_b32 v36, v165, v161, s44
  v_perm_b32 v165, v165, v161, s45
  v_mov_b32 v161, v36
  v_perm_b32 v36, v166, v162, s44
  v_perm_b32 v166, v166, v162, s45
  v_mov_b32 v162, v36
  v_perm_b32 v36, v167, v163, s44
  v_perm_b32 v167, v167, v163, s45
  v_mov_b32 v163, v36
  v_perm_b32 v36, v172, v168, s44
  v_perm_b32 v172, v172, v168, s45
  v_mov_b32 v168, v36
  v_perm_b32 v36, v173, v169, s44
  v_perm_b32 v173, v173, v169, s45
  v_mov_b32 v169, v36
  v_perm_b32 v36, v174, v170, s44
  v_perm_b32 v174, v174, v170, s45
  v_mov_b32 v170, v36
  v_perm_b32 v36, v175, v171, s44
  v_perm_b32 v175, v175, v171, s45
  v_mov_b32 v171, v36
  v_perm_b32 v36, v180, v176, s44
  v_perm_b32 v180, v180, v176, s45
  v_mov_b32 v176, v36
  v_perm_b32 v36, v181, v177, s44
  v_perm_b32 v181, v181, v177, s45
  v_mov_b32 v177, v36
  v_perm_b32 v36, v182, v178, s44
  v_perm_b32 v182, v182, v178, s45
  v_mov_b32 v178, v36
  v_perm_b32 v36, v183, v179, s44
  v_perm_b32 v183, v183, v179, s45
  v_mov_b32 v179, v36
  v_perm_b32 v36, v188, v184, s44
  v_perm_b32 v188, v188, v184, s45
  v_mov_b32 v184, v36
  v_perm_b32 v36, v189, v185, s44
  v_perm_b32 v189, v189, v185, s45
  v_mov_b32 v185, v36
  v_perm_b32 v36, v190, v186, s44
  v_perm_b32 v190, v190, v186, s45
  v_mov_b32 v186, v36
  v_perm_b32 v36, v191, v187, s44
  v_perm_b32 v191, v191, v187, s45
  v_mov_b32 v187, v36
  s_cmp_lg_u32 s3, 0
  s_cbranch_scc1 A_f1seen
  s_mov_b32 s44, 21
H_prog5:
  ds_read_b32 v62, v60 offset:32
  s_waitcnt lgkmcnt(0)
  v_readfirstlane_b32 s48, v62
  s_nop 1
  s_cmp_ge_u32 s48, s44
  s_cbranch_scc1 H_prog5_ok
  s_sleep 16
  s_branch H_prog5
H_prog5_ok:
  v_mov_b32 v6, 128
  global_load_dword v62, v6, s[24:25] sc1
  s_waitcnt vmcnt(0)
  v_readfirstlane_b32 s48, v62
  s_nop 1
  s_cmp_lt_u32 s48, 172
  s_cbranch_scc1 A_f1seen
  ds_write_b32 v60, v61 offset:52
A_f1seen:
  s_mov_b32 s53, 0x3fb8aa3b
  v_mov_b32 v28, 0
  v_mov_b32 v29, 0
  v_mov_b32 v30, 0
  v_mov_b32 v31, 0
  v_mov_b32 v32, 0
  v_mov_b32 v33, 0
  v_mov_b32 v34, 0
  v_mov_b32 v35, 0
  v_mov_b32 v6, 0
  s_lshl_b32 s48, s3, 7
  v_lshl_add_u32 v7, v4, 2, s48
  s_waitcnt vmcnt(0)
  s_barrier
  s_cmp_lg_u32 s3, 0
  s_cbranch_scc1 A_notk
  v_mov_b32 v9, 140
  s_mov_b64 exec, 1
  global_atomic_add v8, v9, v61, s[24:25] sc0
  s_mov_b64 exec, -1
A_notk:
  ds_read_b128 v[36:39], v6 offset:512
  ds_read_b128 v[40:43], v6 offset:528
  ds_read_b32 v44, v7 offset:1024
  ds_read_b32 v48, v7 offset:1088
  ds_read_b32 v45, v7 offset:1536
  ds_read_b32 v49, v7 offset:1600
  ds_read_b32 v46, v7 offset:2048
  ds_read_b32 v50, v7 offset:2112
  ds_read_b32 v47, v7 offset:2560
  ds_read_b32 v51, v7 offset:2624
  s_waitcnt lgkmcnt(8)
  v_max_f32 v52, v36, v38
  v_max_f32 v53, v40, v42
  v_max_f32 v52, v52, v53
  v_sub_f32 v36, v36, v52
  v_sub_f32 v38, v38, v52
  v_sub_f32 v40, v40, v52
  v_sub_f32 v42, v42, v52
  v_mul_f32 v36, s53, v36
  v_mul_f32 v38, s53, v38
  v_mul_f32 v40, s53, v40
  v_mul_f32 v42, s53, v42
  v_exp_f32 v36, v36
  v_exp_f32 v38, v38
  v_exp_f32 v40, v40
  v_exp_f32 v42, v42
  v_mul_f32 v53, v36, v37
  v_fmac_f32 v53, v38, v39
  v_fmac_f32 v53, v40, v41
  v_fmac_f32 v53, v42, v43
  s_waitcnt lgkmcnt(0)
  v_mul_f32 v54, v36, v44
  v_mul_f32 v55, v36, v48
  v_fmac_f32 v54, v38, v45
  v_fmac_f32 v55, v38, v49
  v_fmac_f32 v54, v40, v46
  v_fmac_f32 v55, v40, v50
  v_fmac_f32 v54, v42, v47
  v_fmac_f32 v55, v42, v51
  s_nop 0
  v_mov_b32_dpp v56, v54 quad_perm:[1,0,3,2] row_mask:0xf bank_mask:0xf
  v_mov_b32_dpp v57, v55 quad_perm:[1,0,3,2] row_mask:0xf bank_mask:0xf
  v_cvt_pk_bf16_f32 v56, v54, v56
  v_cvt_pk_bf16_f32 v57, v55, v57
  s_nop 0
  v_dot2c_f32_bf16_dpp v28, v56, v64 row_newbcast:0 row_mask:0xf bank_mask:0xf
  v_dot2c_f32_bf16_dpp v29, v56, v68 row_newbcast:0 row_mask:0xf bank_mask:0xf
  v_dot2c_f32_bf16_dpp v30, v56, v65 row_newbcast:0 row_mask:0xf bank_mask:0xf
  v_dot2c_f32_bf16_dpp v31, v56, v69 row_newbcast:0 row_mask:0xf bank_mask:0xf
  v_dot2c_f32_bf16_dpp v32, v56, v66 row_newbcast:0 row_mask:0xf bank_mask:0xf
  v_dot2c_f32_bf16_dpp v33, v56, v70 row_newbcast:0 row_mask:0xf bank_mask:0xf
  v_dot2c_f32_bf16_dpp v34, v56, v67 row_newbcast:0 row_mask:0xf bank_mask:0xf
  v_dot2c_f32_bf16_dpp v35, v56, v71 row_newbcast:0 row_mask:0xf bank_mask:0xf
  v_dot2c_f32_bf16_dpp v28, v56, v72 row_newbcast:2 row_mask:0xf bank_mask:0xf
  v_dot2c_f32_bf16_dpp v29, v56, v76 row_newbcast:2 row_mask:0xf bank_mask:0xf
  v_dot2c_f32_bf16_dpp v30, v56, v73 row_newbcast:2 row_mask:0xf bank_mask:0xf
  v_dot2c_f32_bf16_dpp v31, v56, v77 row_newbcast:2 row_mask:0xf bank_mask:0xf
  v_dot2c_f32_bf16_dpp v32, v56, v74 row_newbcast:2 row_mask:0xf bank_mask:0xf
  v_dot2c_f32_bf16_dpp v33, v56, v78 row_newbcast:2 row_mask:0xf bank_mask:0xf
  v_dot2c_f32_bf16_dpp v34, v56, v75 row_newbcast:2 row_mask:0xf bank_mask:0xf
  v_dot2c_f32_bf16_dpp v35, v56, v79 row_newbcast:2 row_mask:0xf bank_mask:0xf
  v_dot2c_f32_bf16_dpp v28, v56, v80 row_newbcast:4 row_mask:0xf bank_mask:0xf
  v_dot2c_f32_bf16_dpp v29, v56, v84 row_newbcast:4 row_mask:0xf bank_mask:0xf
  v_dot2c_f32_bf16_dpp v30, v56, v81 row_newbcast:4 row_mask:0xf bank_mask:0xf
  v_dot2c_f32_bf16_dpp v31, v56, v85 row_newbcast:4 row_mask:0xf bank_mask:0xf
  v_dot2c_f32_bf16_dpp v32, v56, v82 row_newbcast:4 row_mask:0xf bank_mask:0xf
  v_dot2c_f32_bf16_dpp v33, v56, v86 row_newbcast:4 row_mask:0xf bank_mask:0xf
  v_dot2c_f32_bf16_dpp v34, v56, v83 row_newbcast:4 row_mask:0xf bank_mask:0xf
  v_dot2c_f32_bf16_dpp v35, v56, v87 row_newbcast:4 row_mask:0xf bank_mask:0xf
  v_dot2c_f32_bf16_dpp v28, v56, v88 row_newbcast:6 row_mask:0xf bank_mask:0xf
  v_dot2c_f32_bf16_dpp v29, v56, v92 row_newbcast:6 row_mask:0xf bank_mask:0xf
  v_dot2c_f32_bf16_dpp v30, v56, v89 row_newbcast:6 row_mask:0xf bank_mask:0xf
  v_dot2c_f32_bf16_dpp v31, v56, v93 row_newbcast:6 row_mask:0xf bank_mask:0xf
  v_dot2c_f32_bf16_dpp v32, v56, v90 row_newbcast:6 row_mask:0xf bank_mask:0xf
  v_dot2c_f32_bf16_dpp v33, v56, v94 row_newbcast:6 row_mask:0xf bank_mask:0xf
  v_dot2c_f32_bf16_dpp v34, v56, v91 row_newbcast:6 row_mask:0xf bank_mask:0xf
  v_dot2c_f32_bf16_dpp v35, v56, v95 row_newbcast:6 row_mask:0xf bank_mask:0xf
  v_dot2c_f32_bf16_dpp v28, v56, v96 row_newbcast:8 row_mask:0xf bank_mask:0xf
  v_dot2c_f32_bf16_dpp v29, v56, v100 row_newbcast:8 row_mask:0xf bank_mask:0xf
  v_dot2c_f32_bf16_dpp v30, v56, v97 row_newbcast:8 row_mask:0xf bank_mask:0xf
  v_dot2c_f32_bf16_dpp v31, v56, v101 row_newbcast:8 row_mask:0xf bank_mask:0xf
  v_dot2c_f32_bf16_dpp v32, v56, v98 row_newbcast:8 row_mask:0xf bank_mask:0xf
  v_dot2c_f32_bf16_dpp v33, v56, v102 row_newbcast:8 row_mask:0xf bank_mask:0xf
  v_dot2c_f32_bf16_dpp v34, v56, v99 row_newbcast:8 row_mask:0xf bank_mask:0xf
  v_dot2c_f32_bf16_dpp v35, v56, v103 row_newbcast:8 row_mask:0xf bank_mask:0xf
  v_dot2c_f32_bf16_dpp v28, v56, v104 row_newbcast:10 row_mask:0xf bank_mask:0xf
  v_dot2c_f32_bf16_dpp v29, v56, v108 row_newbcast:10 row_mask:0xf bank_mask:0xf
  v_dot2c_f32_bf16_dpp v30, v56, v105 row_newbcast:10 row_mask:0xf bank_mask:0xf
  v_dot2c_f32_bf16_dpp v31, v56, v109 row_newbcast:10 row_mask:0xf bank_mask:0xf
  v_dot2c_f32_bf16_dpp v32, v56, v106 row_newbcast:10 row_mask:0xf bank_mask:0xf
  v_dot2c_f32_bf16_dpp v33, v56, v110 row_newbcast:10 row_mask:0xf bank_mask:0xf
  v_dot2c_f32_bf16_dpp v34, v56, v107 row_newbcast:10 row_mask:0xf bank_mask:0xf
  v_dot2c_f32_bf16_dpp v35, v56, v111 row_newbcast:10 row_mask:0xf bank_mask:0xf
  v_dot2c_f32_bf16_dpp v28, v56, v112 row_newbcast:12 row_mask:0xf bank_mask:0xf
  v_dot2c_f32_bf16_dpp v29, v56, v116 row_newbcast:12 row_mask:0xf bank_mask:0xf
  v_dot2c_f32_bf16_dpp v30, v56, v113 row_newbcast:12 row_mask:0xf bank_mask:0xf
  v_dot2c_f32_bf16_dpp v31, v56, v117 row_newbcast:12 row_mask:0xf bank_mask:0xf
  v_dot2c_f32_bf16_dpp v32, v56, v114 row_newbcast:12 row_mask:0xf bank_mask:0xf
  v_dot2c_f32_bf16_dpp v33, v56, v118 row_newbcast:12 row_mask:0xf bank_mask:0xf
  v_dot2c_f32_bf16_dpp v34, v56, v115 row_newbcast:12 row_mask:0xf bank_mask:0xf
  v_dot2c_f32_bf16_dpp v35, v56, v119 row_newbcast:12 row_mask:0xf bank_mask:0xf
  v_dot2c_f32_bf16_dpp v28, v56, v120 row_newbcast:14 row_mask:0xf bank_mask:0xf
  v_dot2c_f32_bf16_dpp v29, v56, v124 row_newbcast:14 row_mask:0xf bank_mask:0xf
  v_dot2c_f32_bf16_dpp v30, v56, v121 row_newbcast:14 row_mask:0xf bank_mask:0xf
  v_dot2c_f32_bf16_dpp v31, v56, v125 row_newbcast:14 row_mask:0xf bank_mask:0xf
  v_dot2c_f32_bf16_dpp v32, v56, v122 row_newbcast:14 row_mask:0xf bank_mask:0xf
  v_dot2c_f32_bf16_dpp v33, v56, v126 row_newbcast:14 row_mask:0xf bank_mask:0xf
  v_dot2c_f32_bf16_dpp v34, v56, v123 row_newbcast:14 row_mask:0xf bank_mask:0xf
  v_dot2c_f32_bf16_dpp v35, v56, v127 row_newbcast:14 row_mask:0xf bank_mask:0xf
  v_dot2c_f32_bf16_dpp v28, v57, v128 row_newbcast:0 row_mask:0xf bank_mask:0xf
  v_dot2c_f32_bf16_dpp v29, v57, v132 row_newbcast:0 row_mask:0xf bank_mask:0xf
  v_dot2c_f32_bf16_dpp v30, v57, v129 row_newbcast:0 row_mask:0xf bank_mask:0xf
  v_dot2c_f32_bf16_dpp v31, v57, v133 row_newbcast:0 row_mask:0xf bank_mask:0xf
  v_dot2c_f32_bf16_dpp v32, v57, v130 row_newbcast:0 row_mask:0xf bank_mask:0xf
  v_dot2c_f32_bf16_dpp v33, v57, v134 row_newbcast:0 row_mask:0xf bank_mask:0xf
  v_dot2c_f32_bf16_dpp v34, v57, v131 row_newbcast:0 row_mask:0xf bank_mask:0xf
  v_dot2c_f32_bf16_dpp v35, v57, v135 row_newbcast:0 row_mask:0xf bank_mask:0xf
  v_dot2c_f32_bf16_dpp v28, v57, v136 row_newbcast:2 row_mask:0xf bank_mask:0xf
  v_dot2c_f32_bf16_dpp v29, v57, v140 row_newbcast:2 row_mask:0xf bank_mask:0xf
  v_dot2c_f32_bf16_dpp v30, v57, v137 row_newbcast:2 row_mask:0xf bank_mask:0xf
  v_dot2c_f32_bf16_dpp v31, v57, v141 row_newbcast:2 row_mask:0xf bank_mask:0xf
  v_dot2c_f32_bf16_dpp v32, v57, v138 row_newbcast:2 row_mask:0xf bank_mask:0xf
  v_dot2c_f32_bf16_dpp v33, v57, v142 row_newbcast:2 row_mask:0xf bank_mask:0xf
  v_dot2c_f32_bf16_dpp v34, v57, v139 row_newbcast:2 row_mask:0xf bank_mask:0xf
  v_dot2c_f32_bf16_dpp v35, v57, v143 row_newbcast:2 row_mask:0xf bank_mask:0xf
  v_dot2c_f32_bf16_dpp v28, v57, v144 row_newbcast:4 row_mask:0xf bank_mask:0xf
  v_dot2c_f32_bf16_dpp v29, v57, v148 row_newbcast:4 row_mask:0xf bank_mask:0xf
  v_dot2c_f32_bf16_dpp v30, v57, v145 row_newbcast:4 row_mask:0xf bank_mask:0xf
  v_dot2c_f32_bf16_dpp v31, v57, v149 row_newbcast:4 row_mask:0xf bank_mask:0xf
  v_dot2c_f32_bf16_dpp v32, v57, v146 row_newbcast:4 row_mask:0xf bank_mask:0xf
  v_dot2c_f32_bf16_dpp v33, v57, v150 row_newbcast:4 row_mask:0xf bank_mask:0xf
  v_dot2c_f32_bf16_dpp v34, v57, v147 row_newbcast:4 row_mask:0xf bank_mask:0xf
  v_dot2c_f32_bf16_dpp v35, v57, v151 row_newbcast:4 row_mask:0xf bank_mask:0xf
  v_dot2c_f32_bf16_dpp v28, v57, v152 row_newbcast:6 row_mask:0xf bank_mask:0xf
  v_dot2c_f32_bf16_dpp v29, v57, v156 row_newbcast:6 row_mask:0xf bank_mask:0xf
  v_dot2c_f32_bf16_dpp v30, v57, v153 row_newbcast:6 row_mask:0xf bank_mask:0xf
  v_dot2c_f32_bf16_dpp v31, v57, v157 row_newbcast:6 row_mask:0xf bank_mask:0xf
  v_dot2c_f32_bf16_dpp v32, v57, v154 row_newbcast:6 row_mask:0xf bank_mask:0xf
  v_dot2c_f32_bf16_dpp v33, v57, v158 row_newbcast:6 row_mask:0xf bank_mask:0xf
  v_dot2c_f32_bf16_dpp v34, v57, v155 row_newbcast:6 row_mask:0xf bank_mask:0xf
  v_dot2c_f32_bf16_dpp v35, v57, v159 row_newbcast:6 row_mask:0xf bank_mask:0xf
  v_dot2c_f32_bf16_dpp v28, v57, v160 row_newbcast:8 row_mask:0xf bank_mask:0xf
  v_dot2c_f32_bf16_dpp v29, v57, v164 row_newbcast:8 row_mask:0xf bank_mask:0xf
  v_dot2c_f32_bf16_dpp v30, v57, v161 row_newbcast:8 row_mask:0xf bank_mask:0xf
  v_dot2c_f32_bf16_dpp v31, v57, v165 row_newbcast:8 row_mask:0xf bank_mask:0xf
  v_dot2c_f32_bf16_dpp v32, v57, v162 row_newbcast:8 row_mask:0xf bank_mask:0xf
  v_dot2c_f32_bf16_dpp v33, v57, v166 row_newbcast:8 row_mask:0xf bank_mask:0xf
  v_dot2c_f32_bf16_dpp v34, v57, v163 row_newbcast:8 row_mask:0xf bank_mask:0xf
  v_dot2c_f32_bf16_dpp v35, v57, v167 row_newbcast:8 row_mask:0xf bank_mask:0xf
  v_dot2c_f32_bf16_dpp v28, v57, v168 row_newbcast:10 row_mask:0xf bank_mask:0xf
  v_dot2c_f32_bf16_dpp v29, v57, v172 row_newbcast:10 row_mask:0xf bank_mask:0xf
  v_dot2c_f32_bf16_dpp v30, v57, v169 row_newbcast:10 row_mask:0xf bank_mask:0xf
  v_dot2c_f32_bf16_dpp v31, v57, v173 row_newbcast:10 row_mask:0xf bank_mask:0xf
  v_dot2c_f32_bf16_dpp v32, v57, v170 row_newbcast:10 row_mask:0xf bank_mask:0xf
  v_dot2c_f32_bf16_dpp v33, v57, v174 row_newbcast:10 row_mask:0xf bank_mask:0xf
  v_dot2c_f32_bf16_dpp v34, v57, v171 row_newbcast:10 row_mask:0xf bank_mask:0xf
  v_dot2c_f32_bf16_dpp v35, v57, v175 row_newbcast:10 row_mask:0xf bank_mask:0xf
  v_dot2c_f32_bf16_dpp v28, v57, v176 row_newbcast:12 row_mask:0xf bank_mask:0xf
  v_dot2c_f32_bf16_dpp v29, v57, v180 row_newbcast:12 row_mask:0xf bank_mask:0xf
  v_dot2c_f32_bf16_dpp v30, v57, v177 row_newbcast:12 row_mask:0xf bank_mask:0xf
  v_dot2c_f32_bf16_dpp v31, v57, v181 row_newbcast:12 row_mask:0xf bank_mask:0xf
  v_dot2c_f32_bf16_dpp v32, v57, v178 row_newbcast:12 row_mask:0xf bank_mask:0xf
  v_dot2c_f32_bf16_dpp v33, v57, v182 row_newbcast:12 row_mask:0xf bank_mask:0xf
  v_dot2c_f32_bf16_dpp v34, v57, v179 row_newbcast:12 row_mask:0xf bank_mask:0xf
  v_dot2c_f32_bf16_dpp v35, v57, v183 row_newbcast:12 row_mask:0xf bank_mask:0xf
  v_dot2c_f32_bf16_dpp v28, v57, v184 row_newbcast:14 row_mask:0xf bank_mask:0xf
  v_dot2c_f32_bf16_dpp v29, v57, v188 row_newbcast:14 row_mask:0xf bank_mask:0xf
  v_dot2c_f32_bf16_dpp v30, v57, v185 row_newbcast:14 row_mask:0xf bank_mask:0xf
  v_dot2c_f32_bf16_dpp v31, v57, v189 row_newbcast:14 row_mask:0xf bank_mask:0xf
  v_dot2c_f32_bf16_dpp v32, v57, v186 row_newbcast:14 row_mask:0xf bank_mask:0xf
  v_dot2c_f32_bf16_dpp v33, v57, v190 row_newbcast:14 row_mask:0xf bank_mask:0xf
  v_dot2c_f32_bf16_dpp v34, v57, v187 row_newbcast:14 row_mask:0xf bank_mask:0xf
  v_dot2c_f32_bf16_dpp v35, v57, v191 row_newbcast:14 row_mask:0xf bank_mask:0xf
  s_lshl_b32 s48, s3, 11
  v_lshl_add_u32 v7, v1, 5, s48
  ds_write_b128 v7, v[28:31] offset:23552
  ds_write_b128 v7, v[32:35] offset:23568
  s_cmp_lg_u32 s3, 0
  s_cbranch_scc1 A_noml
  s_lshl_b32 s48, s46, 3
  s_add_u32 s48, s48, 524288
  v_mov_b32 v6, s48
  v_cmp_eq_u32 vcc, 0, v1
  s_nop 1
  s_and_saveexec_b64 s[56:57], vcc
  global_store_dwordx2 v6, v[52:53], s[26:27]
  s_mov_b64 exec, s[56:57]
  s_waitcnt vmcnt(1)
  s_mov_b64 exec, 1
  ds_write_b32 v60, v8 offset:56
  s_mov_b64 exec, -1
A_noml:
  s_waitcnt lgkmcnt(0)
A_join:
  s_barrier
  v_lshlrev_b32 v7, 2, v0
  ds_read_b32 v8, v7 offset:23552
  ds_read_b32 v9, v7 offset:25600
  ds_read_b32 v10, v7 offset:27648
  ds_read_b32 v11, v7 offset:29696
  s_lshl_b32 s48, s46, 11
  v_add_u32 v6, s48, v7
  s_waitcnt lgkmcnt(0)
  v_add_f32 v8, v8, v9
  v_add_f32 v10, v10, v11
  v_add_f32 v8, v8, v10
  global_store_dword v6, v8, s[26:27] offset:0
  v_lshrrev_b32 v2, 6, v0
  s_nop 0
  v_readfirstlane_b32 s3, v2
  s_nop 1
  s_cmp_ge_u32 s3, 4
  s_cbranch_scc1 A_fin
  ds_read_b32 v36, v60 offset:56
  s_waitcnt lgkmcnt(0)
  v_readfirstlane_b32 s49, v36
  s_nop 1
  s_cmp_ge_u32 s49, 43
  s_cbranch_scc1 A_fin
  s_lshl_b32 s44, s49, 5
  s_lshl_b32 s45, s3, 3
  s_add_u32 s44, s44, s45
  s_lshl_b32 s44, s44, 10
  s_add_u32 s28, s20, s44
  s_addc_u32 s29, s21, 0
  s_mov_b32 s30, 0x2000
  s_mov_b32 s31, 0x20000
  s_mov_b32 s36, 4096
  ds_read_b32 v62, v60 offset:52
  s_waitcnt lgkmcnt(0)
  v_readfirstlane_b32 s48, v62
  s_nop 1
  s_cmp_lg_u32 s48, 0
  s_cbranch_scc1 F2_go
  s_cmp_lg_u32 s3, 0
  s_cbranch_scc1 F2_wait
  v_mov_b32 v6, 128
H_poll6:
  global_load_dword v62, v6, s[24:25] sc1
  s_waitcnt vmcnt(0)
  v_readfirstlane_b32 s48, v62
  s_nop 1
  s_cmp_ge_u32 s48, 172
  s_cbranch_scc1 H_poll6_ok
  s_sleep 4
  s_branch H_poll6
H_poll6_ok:
F2_wait:
  s_waitcnt lgkmcnt(0)
  s_mov_b64 exec, 1
  ds_add_u32 v60, v61 offset:20
  s_mov_b64 exec, -1
H_sync7:
  ds_read_b32 v62, v60 offset:20
  s_waitcnt lgkmcnt(0)
  v_readfirstlane_b32 s48, v62
  s_nop 1
  s_cmp_ge_u32 s48, 4
  s_cbranch_scc1 H_sync7_ok
  s_sleep 2
  s_branch H_sync7
H_sync7_ok:
F2_go:
  s_lshl_b32 s44, s49, 12
  s_add_u32 s44, s44, 1572864
  v_add_u32 v6, s44, v5
  global_load_dwordx4 v[36:39], v6, s[26:27] offset:0 sc1
  global_load_dwordx4 v[40:43], v6, s[26:27] offset:1024 sc1
  global_load_dwordx4 v[44:47], v6, s[26:27] offset:2048 sc1
  global_load_dwordx4 v[48:51], v6, s[26:27] offset:3072 sc1
  buffer_load_dwordx4 v[128:131], v5, s[28:31], 0 offen offset:0
  buffer_load_dwordx4 v[132:135], v5, s[28:31], 0 offen offset:1024
  buffer_load_dwordx4 v[136:139], v5, s[28:31], 0 offen offset:2048
  buffer_load_dwordx4 v[140:143], v5, s[28:31], 0 offen offset:3072
  buffer_load_dwordx4 v[144:147], v5, s[28:31], s36 offen offset:0
  buffer_load_dwordx4 v[148:151], v5, s[28:31], s36 offen offset:1024
  buffer_load_dwordx4 v[152:155], v5, s[28:31], s36 offen offset:2048
  buffer_load_dwordx4 v[156:159], v5, s[28:31], s36 offen offset:3072
  v_mov_b32 v192, 0
  v_mov_b32 v193, 0
  v_mov_b32 v194, 0
  v_mov_b32 v195, 0
  v_mov_b32 v196, 0
  v_mov_b32 v197, 0
  v_mov_b32 v198, 0
  v_mov_b32 v199, 0
  v_mov_b32 v200, 0
  v_mov_b32 v201, 0
  v_mov_b32 v202, 0
  v_mov_b32 v203, 0
  v_mov_b32 v204, 0
  v_mov_b32 v205, 0
  v_mov_b32 v206, 0
  v_mov_b32 v207, 0
  v_mov_b32 v208, 0
  v_mov_b32 v209, 0
  v_mov_b32 v210, 0
  v_mov_b32 v211, 0
  v_mov_b32 v212, 0
  v_mov_b32 v213, 0
  v_mov_b32 v214, 0
  v_mov_b32 v215, 0
  v_mov_b32 v216, 0
  v_mov_b32 v217, 0
  v_mov_b32 v218, 0
  v_mov_b32 v219, 0
  v_mov_b32 v220, 0
  v_mov_b32 v221, 0
  v_mov_b32 v222, 0
  v_mov_b32 v223, 0
  s_waitcnt vmcnt(8)
  v_add_f32 v36, v36, v40
  v_add_f32 v44, v44, v48
  v_add_f32 v37, v37, v41
  v_add_f32 v45, v45, v49
  v_add_f32 v38, v38, v42
  v_add_f32 v46, v46, v50
  v_add_f32 v39, v39, v43
  v_add_f32 v47, v47, v51
  v_add_f32 v36, v36, v44
  v_add_f32 v37, v37, v45
  v_add_f32 v38, v38, v46
  v_add_f32 v39, v39, v47
  s_mov_b32 s44, 0x3d372713
  v_cvt_pk_bf16_f32 v52, v36, v36
  v_and_b32 v36, 0xffff0000, v52
  v_cvt_pk_bf16_f32 v52, v38, v38
  v_and_b32 v38, 0xffff0000, v52
  v_mul_f32 v52, v36, v36
  v_mul_f32 v52, v52, v36
  v_fma_f32 v52, v52, s44, v36
  v_mul_f32 v52, 0xc0135761, v52
  v_exp_f32 v52, v52
  s_nop 0
  v_add_f32 v52, 1.0, v52
  v_rcp_f32 v52, v52
  s_nop 0
  v_mul_f32 v36, v36, v52
  v_cvt_pk_bf16_f32 v52, v36, v36
  v_and_b32 v36, 0xffff0000, v52
  v_mul_f32 v36, v36, v38
  v_cvt_pk_bf16_f32 v52, v36, v36
  v_and_b32 v36, 0xffff0000, v52
  v_lshrrev_b32 v40, 16, v36
  v_cvt_pk_bf16_f32 v52, v37, v37
  v_and_b32 v37, 0xffff0000, v52
  v_cvt_pk_bf16_f32 v52, v39, v39
  v_and_b32 v39, 0xffff0000, v52
  v_mul_f32 v52, v37, v37
  v_mul_f32 v52, v52, v37
  v_fma_f32 v52, v52, s44, v37
  v_mul_f32 v52, 0xc0135761, v52
  v_exp_f32 v52, v52
  s_nop 0
  v_add_f32 v52, 1.0, v52
  v_rcp_f32 v52, v52
  s_nop 0
  v_mul_f32 v37, v37, v52
  v_cvt_pk_bf16_f32 v52, v37, v37
  v_and_b32 v37, 0xffff0000, v52
  v_mul_f32 v37, v37, v39
  v_cvt_pk_bf16_f32 v52, v37, v37
  v_and_b32 v37, 0xffff0000, v52
  v_lshrrev_b32 v41, 16, v37
  s_add_u32 s45, s3, 0
  v_readlane_b32 s64, v40, s45
  v_readlane_b32 s65, v36, s45
  s_add_u32 s45, s3, 0
  v_readlane_b32 s66, v41, s45
  v_readlane_b32 s67, v37, s45
  s_add_u32 s45, s3, 4
  v_readlane_b32 s68, v40, s45
  v_readlane_b32 s69, v36, s45
  s_add_u32 s45, s3, 4
  v_readlane_b32 s70, v41, s45
  v_readlane_b32 s71, v37, s45
  s_add_u32 s45, s3, 8
  v_readlane_b32 s72, v40, s45
  v_readlane_b32 s73, v36, s45
  s_add_u32 s45, s3, 8
  v_readlane_b32 s74, v41, s45
  v_readlane_b32 s75, v37, s45
  s_add_u32 s45, s3, 12
  v_readlane_b32 s76, v40, s45
  v_readlane_b32 s77, v36, s45
  s_add_u32 s45, s3, 12
  v_readlane_b32 s78, v41, s45
  v_readlane_b32 s79, v37, s45
  s_waitcnt vmcnt(0)
  v_dot2c_f32_bf16 v192, s64, v128
  v_dot2c_f32_bf16 v193, s65, v128
  v_dot2c_f32_bf16 v194, s64, v129
  v_dot2c_f32_bf16 v195, s65, v129
  v_dot2c_f32_bf16 v196, s64, v130
  v_dot2c_f32_bf16 v197, s65, v130
  v_dot2c_f32_bf16 v198, s64, v131
  v_dot2c_f32_bf16 v199, s65, v131
  v_dot2c_f32_bf16 v192, s66, v132
  v_dot2c_f32_bf16 v193, s67, v132
  v_dot2c_f32_bf16 v194, s66, v133
  v_dot2c_f32_bf16 v195, s67, v133
  v_dot2c_f32_bf16 v196, s66, v134
  v_dot2c_f32_bf16 v197, s67, v134
  v_dot2c_f32_bf16 v198, s66, v135
  v_dot2c_f32_bf16 v199, s67, v135
  v_dot2c_f32_bf16 v192, s68, v136
  v_dot2c_f32_bf16 v193, s69, v136
  v_dot2c_f32_bf16 v194, s68, v137
  v_dot2c_f32_bf16 v195, s69, v137
  v_dot2c_f32_bf16 v196, s68, v138
  v_dot2c_f32_bf16 v197, s69, v138
  v_dot2c_f32_bf16 v198, s68, v139
  v_dot2c_f32_bf16 v199, s69, v139
  v_dot2c_f32_bf16 v192, s70, v140
  v_dot2c_f32_bf16 v193, s71, v140
  v_dot2c_f32_bf16 v194, s70, v141
  v_dot2c_f32_bf16 v195, s71, v141
  v_dot2c_f32_bf16 v196, s70, v142
  v_dot2c_f32_bf16 v197, s71, v142
  v_dot2c_f32_bf16 v198, s70, v143
  v_dot2c_f32_bf16 v199, s71, v143
  v_dot2c_f32_bf16 v192, s72, v144
  v_dot2c_f32_bf16 v193, s73, v144
  v_dot2c_f32_bf16 v194, s72, v145
  v_dot2c_f32_bf16 v195, s73, v145
  v_dot2c_f32_bf16 v196, s72, v146
  v_dot2c_f32_bf16 v197, s73, v146
  v_dot2c_f32_bf16 v198, s72, v147
  v_dot2c_f32_bf16 v199, s73, v147
  v_dot2c_f32_bf16 v192, s74, v148
  v_dot2c_f32_bf16 v193, s75, v148
  v_dot2c_f32_bf16 v194, s74, v149
  v_dot2c_f32_bf16 v195, s75, v149
  v_dot2c_f32_bf16 v196, s74, v150
  v_dot2c_f32_bf16 v197, s75, v150
  v_dot2c_f32_bf16 v198, s74, v151
  v_dot2c_f32_bf16 v199, s75, v151
  v_dot2c_f32_bf16 v192, s76, v152
  v_dot2c_f32_bf16 v193, s77, v152
  v_dot2c_f32_bf16 v194, s76, v153
  v_dot2c_f32_bf16 v195, s77, v153
  v_dot2c_f32_bf16 v196, s76, v154
  v_dot2c_f32_bf16 v197, s77, v154
  v_dot2c_f32_bf16 v198, s76, v155
  v_dot2c_f32_bf16 v199, s77, v155
  v_dot2c_f32_bf16 v192, s78, v156
  v_dot2c_f32_bf16 v193, s79, v156
  v_dot2c_f32_bf16 v194, s78, v157
  v_dot2c_f32_bf16 v195, s79, v157
  v_dot2c_f32_bf16 v196, s78, v158
  v_dot2c_f32_bf16 v197, s79, v158
  v_dot2c_f32_bf16 v198, s78, v159
  v_dot2c_f32_bf16 v199, s79, v159
  s_add_u32 s45, s3, 16
  v_readlane_b32 s64, v40, s45
  v_readlane_b32 s65, v36, s45
  s_add_u32 s45, s3, 16
  v_readlane_b32 s66, v41, s45
  v_readlane_b32 s67, v37, s45
  s_add_u32 s45, s3, 20
  v_readlane_b32 s68, v40, s45
  v_readlane_b32 s69, v36, s45
  s_add_u32 s45, s3, 20
  v_readlane_b32 s70, v41, s45
  v_readlane_b32 s71, v37, s45
  s_add_u32 s45, s3, 24
  v_readlane_b32 s72, v40, s45
  v_readlane_b32 s73, v36, s45
  s_add_u32 s45, s3, 24
  v_readlane_b32 s74, v41, s45
  v_readlane_b32 s75, v37, s45
  s_add_u32 s45, s3, 28
  v_readlane_b32 s76, v40, s45
  v_readlane_b32 s77, v36, s45
  s_add_u32 s45, s3, 28
  v_readlane_b32 s78, v41, s45
  v_readlane_b32 s79, v37, s45
  v_dot2c_f32_bf16 v200, s64, v128
  v_dot2c_f32_bf16 v201, s65, v128
  v_dot2c_f32_bf16 v202, s64, v129
  v_dot2c_f32_bf16 v203, s65, v129
  v_dot2c_f32_bf16 v204, s64, v130
  v_dot2c_f32_bf16 v205, s65, v130
  v_dot2c_f32_bf16 v206, s64, v131
  v_dot2c_f32_bf16 v207, s65, v131
  v_dot2c_f32_bf16 v200, s66, v132
  v_dot2c_f32_bf16 v201, s67, v132
  v_dot2c_f32_bf16 v202, s66, v133
  v_dot2c_f32_bf16 v203, s67, v133
  v_dot2c_f32_bf16 v204, s66, v134
  v_dot2c_f32_bf16 v205, s67, v134
  v_dot2c_f32_bf16 v206, s66, v135
  v_dot2c_f32_bf16 v207, s67, v135
  v_dot2c_f32_bf16 v200, s68, v136
  v_dot2c_f32_bf16 v201, s69, v136
  v_dot2c_f32_bf16 v202, s68, v137
  v_dot2c_f32_bf16 v203, s69, v137
  v_dot2c_f32_bf16 v204, s68, v138
  v_dot2c_f32_bf16 v205, s69, v138
  v_dot2c_f32_bf16 v206, s68, v139
  v_dot2c_f32_bf16 v207, s69, v139
  v_dot2c_f32_bf16 v200, s70, v140
  v_dot2c_f32_bf16 v201, s71, v140
  v_dot2c_f32_bf16 v202, s70, v141
  v_dot2c_f32_bf16 v203, s71, v141
  v_dot2c_f32_bf16 v204, s70, v142
  v_dot2c_f32_bf16 v205, s71, v142
  v_dot2c_f32_bf16 v206, s70, v143
  v_dot2c_f32_bf16 v207, s71, v143
  v_dot2c_f32_bf16 v200, s72, v144
  v_dot2c_f32_bf16 v201, s73, v144
  v_dot2c_f32_bf16 v202, s72, v145
  v_dot2c_f32_bf16 v203, s73, v145
  v_dot2c_f32_bf16 v204, s72, v146
  v_dot2c_f32_bf16 v205, s73, v146
  v_dot2c_f32_bf16 v206, s72, v147
  v_dot2c_f32_bf16 v207, s73, v147
  v_dot2c_f32_bf16 v200, s74, v148
  v_dot2c_f32_bf16 v201, s75, v148
  v_dot2c_f32_bf16 v202, s74, v149
  v_dot2c_f32_bf16 v203, s75, v149
  v_dot2c_f32_bf16 v204, s74, v150
  v_dot2c_f32_bf16 v205, s75, v150
  v_dot2c_f32_bf16 v206, s74, v151
  v_dot2c_f32_bf16 v207, s75, v151
  v_dot2c_f32_bf16 v200, s76, v152
  v_dot2c_f32_bf16 v201, s77, v152
  v_dot2c_f32_bf16 v202, s76, v153
  v_dot2c_f32_bf16 v203, s77, v153
  v_dot2c_f32_bf16 v204, s76, v154
  v_dot2c_f32_bf16 v205, s77, v154
  v_dot2c_f32_bf16 v206, s76, v155
  v_dot2c_f32_bf16 v207, s77, v155
  v_dot2c_f32_bf16 v200, s78, v156
  v_dot2c_f32_bf16 v201, s79, v156
  v_dot2c_f32_bf16 v202, s78, v157
  v_dot2c_f32_bf16 v203, s79, v157
  v_dot2c_f32_bf16 v204, s78, v158
  v_dot2c_f32_bf16 v205, s79, v158
  v_dot2c_f32_bf16 v206, s78, v159
  v_dot2c_f32_bf16 v207, s79, v159
  s_add_u32 s45, s3, 32
  v_readlane_b32 s64, v40, s45
  v_readlane_b32 s65, v36, s45
  s_add_u32 s45, s3, 32
  v_readlane_b32 s66, v41, s45
  v_readlane_b32 s67, v37, s45
  s_add_u32 s45, s3, 36
  v_readlane_b32 s68, v40, s45
  v_readlane_b32 s69, v36, s45
  s_add_u32 s45, s3, 36
  v_readlane_b32 s70, v41, s45
  v_readlane_b32 s71, v37, s45
  s_add_u32 s45, s3, 40
  v_readlane_b32 s72, v40, s45
  v_readlane_b32 s73, v36, s45
  s_add_u32 s45, s3, 40
  v_readlane_b32 s74, v41, s45
  v_readlane_b32 s75, v37, s45
  s_add_u32 s45, s3, 44
  v_readlane_b32 s76, v40, s45
  v_readlane_b32 s77, v36, s45
  s_add_u32 s45, s3, 44
  v_readlane_b32 s78, v41, s45
  v_readlane_b32 s79, v37, s45
  v_dot2c_f32_bf16 v208, s64, v128
  v_dot2c_f32_bf16 v209, s65, v128
  v_dot2c_f32_bf16 v210, s64, v129
  v_dot2c_f32_bf16 v211, s65, v129
  v_dot2c_f32_bf16 v212, s64, v130
  v_dot2c_f32_bf16 v213, s65, v130
  v_dot2c_f32_bf16 v214, s64, v131
  v_dot2c_f32_bf16 v215, s65, v131
  v_dot2c_f32_bf16 v208, s66, v132
  v_dot2c_f32_bf16 v209, s67, v132
  v_dot2c_f32_bf16 v210, s66, v133
  v_dot2c_f32_bf16 v211, s67, v133
  v_dot2c_f32_bf16 v212, s66, v134
  v_dot2c_f32_bf16 v213, s67, v134
  v_dot2c_f32_bf16 v214, s66, v135
  v_dot2c_f32_bf16 v215, s67, v135
  v_dot2c_f32_bf16 v208, s68, v136
  v_dot2c_f32_bf16 v209, s69, v136
  v_dot2c_f32_bf16 v210, s68, v137
  v_dot2c_f32_bf16 v211, s69, v137
  v_dot2c_f32_bf16 v212, s68, v138
  v_dot2c_f32_bf16 v213, s69, v138
  v_dot2c_f32_bf16 v214, s68, v139
  v_dot2c_f32_bf16 v215, s69, v139
  v_dot2c_f32_bf16 v208, s70, v140
  v_dot2c_f32_bf16 v209, s71, v140
  v_dot2c_f32_bf16 v210, s70, v141
  v_dot2c_f32_bf16 v211, s71, v141
  v_dot2c_f32_bf16 v212, s70, v142
  v_dot2c_f32_bf16 v213, s71, v142
  v_dot2c_f32_bf16 v214, s70, v143
  v_dot2c_f32_bf16 v215, s71, v143
  v_dot2c_f32_bf16 v208, s72, v144
  v_dot2c_f32_bf16 v209, s73, v144
  v_dot2c_f32_bf16 v210, s72, v145
  v_dot2c_f32_bf16 v211, s73, v145
  v_dot2c_f32_bf16 v212, s72, v146
  v_dot2c_f32_bf16 v213, s73, v146
  v_dot2c_f32_bf16 v214, s72, v147
  v_dot2c_f32_bf16 v215, s73, v147
  v_dot2c_f32_bf16 v208, s74, v148
  v_dot2c_f32_bf16 v209, s75, v148
  v_dot2c_f32_bf16 v210, s74, v149
  v_dot2c_f32_bf16 v211, s75, v149
  v_dot2c_f32_bf16 v212, s74, v150
  v_dot2c_f32_bf16 v213, s75, v150
  v_dot2c_f32_bf16 v214, s74, v151
  v_dot2c_f32_bf16 v215, s75, v151
  v_dot2c_f32_bf16 v208, s76, v152
  v_dot2c_f32_bf16 v209, s77, v152
  v_dot2c_f32_bf16 v210, s76, v153
  v_dot2c_f32_bf16 v211, s77, v153
  v_dot2c_f32_bf16 v212, s76, v154
  v_dot2c_f32_bf16 v213, s77, v154
  v_dot2c_f32_bf16 v214, s76, v155
  v_dot2c_f32_bf16 v215, s77, v155
  v_dot2c_f32_bf16 v208, s78, v156
  v_dot2c_f32_bf16 v209, s79, v156
  v_dot2c_f32_bf16 v210, s78, v157
  v_dot2c_f32_bf16 v211, s79, v157
  v_dot2c_f32_bf16 v212, s78, v158
  v_dot2c_f32_bf16 v213, s79, v158
  v_dot2c_f32_bf16 v214, s78, v159
  v_dot2c_f32_bf16 v215, s79, v159
  s_add_u32 s45, s3, 48
  v_readlane_b32 s64, v40, s45
  v_readlane_b32 s65, v36, s45
  s_add_u32 s45, s3, 48
  v_readlane_b32 s66, v41, s45
  v_readlane_b32 s67, v37, s45
  s_add_u32 s45, s3, 52
  v_readlane_b32 s68, v40, s45
  v_readlane_b32 s69, v36, s45
  s_add_u32 s45, s3, 52
  v_readlane_b32 s70, v41, s45
  v_readlane_b32 s71, v37, s45
  s_add_u32 s45, s3, 56
  v_readlane_b32 s72, v40, s45
  v_readlane_b32 s73, v36, s45
  s_add_u32 s45, s3, 56
  v_readlane_b32 s74, v41, s45
  v_readlane_b32 s75, v37, s45
  s_add_u32 s45, s3, 60
  v_readlane_b32 s76, v40, s45
  v_readlane_b32 s77, v36, s45
  s_add_u32 s45, s3, 60
  v_readlane_b32 s78, v41, s45
  v_readlane_b32 s79, v37, s45
  v_dot2c_f32_bf16 v216, s64, v128
  v_dot2c_f32_bf16 v217, s65, v128
  v_dot2c_f32_bf16 v218, s64, v129
  v_dot2c_f32_bf16 v219, s65, v129
  v_dot2c_f32_bf16 v220, s64, v130
  v_dot2c_f32_bf16 v221, s65, v130
  v_dot2c_f32_bf16 v222, s64, v131
  v_dot2c_f32_bf16 v223, s65, v131
  v_dot2c_f32_bf16 v216, s66, v132
  v_dot2c_f32_bf16 v217, s67, v132
  v_dot2c_f32_bf16 v218, s66, v133
  v_dot2c_f32_bf16 v219, s67, v133
  v_dot2c_f32_bf16 v220, s66, v134
  v_dot2c_f32_bf16 v221, s67, v134
  v_dot2c_f32_bf16 v222, s66, v135
  v_dot2c_f32_bf16 v223, s67, v135
  v_dot2c_f32_bf16 v216, s68, v136
  v_dot2c_f32_bf16 v217, s69, v136
  v_dot2c_f32_bf16 v218, s68, v137
  v_dot2c_f32_bf16 v219, s69, v137
  v_dot2c_f32_bf16 v220, s68, v138
  v_dot2c_f32_bf16 v221, s69, v138
  v_dot2c_f32_bf16 v222, s68, v139
  v_dot2c_f32_bf16 v223, s69, v139
  v_dot2c_f32_bf16 v216, s70, v140
  v_dot2c_f32_bf16 v217, s71, v140
  v_dot2c_f32_bf16 v218, s70, v141
  v_dot2c_f32_bf16 v219, s71, v141
  v_dot2c_f32_bf16 v220, s70, v142
  v_dot2c_f32_bf16 v221, s71, v142
  v_dot2c_f32_bf16 v222, s70, v143
  v_dot2c_f32_bf16 v223, s71, v143
  v_dot2c_f32_bf16 v216, s72, v144
  v_dot2c_f32_bf16 v217, s73, v144
  v_dot2c_f32_bf16 v218, s72, v145
  v_dot2c_f32_bf16 v219, s73, v145
  v_dot2c_f32_bf16 v220, s72, v146
  v_dot2c_f32_bf16 v221, s73, v146
  v_dot2c_f32_bf16 v222, s72, v147
  v_dot2c_f32_bf16 v223, s73, v147
  v_dot2c_f32_bf16 v216, s74, v148
  v_dot2c_f32_bf16 v217, s75, v148
  v_dot2c_f32_bf16 v218, s74, v149
  v_dot2c_f32_bf16 v219, s75, v149
  v_dot2c_f32_bf16 v220, s74, v150
  v_dot2c_f32_bf16 v221, s75, v150
  v_dot2c_f32_bf16 v222, s74, v151
  v_dot2c_f32_bf16 v223, s75, v151
  v_dot2c_f32_bf16 v216, s76, v152
  v_dot2c_f32_bf16 v217, s77, v152
  v_dot2c_f32_bf16 v218, s76, v153
  v_dot2c_f32_bf16 v219, s77, v153
  v_dot2c_f32_bf16 v220, s76, v154
  v_dot2c_f32_bf16 v221, s77, v154
  v_dot2c_f32_bf16 v222, s76, v155
  v_dot2c_f32_bf16 v223, s77, v155
  v_dot2c_f32_bf16 v216, s78, v156
  v_dot2c_f32_bf16 v217, s79, v156
  v_dot2c_f32_bf16 v218, s78, v157
  v_dot2c_f32_bf16 v219, s79, v157
  v_dot2c_f32_bf16 v220, s78, v158
  v_dot2c_f32_bf16 v221, s79, v158
  v_dot2c_f32_bf16 v222, s78, v159
  v_dot2c_f32_bf16 v223, s79, v159
  s_lshl_b32 s44, s3, 13
  v_lshl_add_u32 v6, v1, 5, s44
  ds_write_b128 v6, v[192:195] offset:31744
  ds_write_b128 v6, v[196:199] offset:31760
  ds_write_b128 v6, v[200:203] offset:33792
  ds_write_b128 v6, v[204:207] offset:33808
  ds_write_b128 v6, v[208:211] offset:35840
  ds_write_b128 v6, v[212:215] offset:35856
  ds_write_b128 v6, v[216:219] offset:37888
  ds_write_b128 v6, v[220:223] offset:37904
  s_waitcnt lgkmcnt(0)
  s_mov_b64 exec, 1
  ds_add_u32 v60, v61 offset:16
  s_mov_b64 exec, -1
H_sync8:
  ds_read_b32 v62, v60 offset:16
  s_waitcnt lgkmcnt(0)
  v_readfirstlane_b32 s48, v62
  s_nop 1
  s_cmp_lt_u32 s48, 4
  s_cbranch_scc1 H_sync8
  v_lshlrev_b32 v7, 5, v0
  ds_read_b128 v[64:67], v7 offset:31744
  ds_read_b128 v[68:71], v7 offset:31760
  ds_read_b128 v[72:75], v7 offset:39936
  ds_read_b128 v[76:79], v7 offset:39952
  ds_read_b128 v[80:83], v7 offset:48128
  ds_read_b128 v[84:87], v7 offset:48144
  ds_read_b128 v[88:91], v7 offset:56320
  ds_read_b128 v[92:95], v7 offset:56336
  s_waitcnt lgkmcnt(0)
  v_add_f32 v64, v64, v72
  v_add_f32 v80, v80, v88
  v_add_f32 v65, v65, v73
  v_add_f32 v81, v81, v89
  v_add_f32 v66, v66, v74
  v_add_f32 v82, v82, v90
  v_add_f32 v67, v67, v75
  v_add_f32 v83, v83, v91
  v_add_f32 v68, v68, v76
  v_add_f32 v84, v84, v92
  v_add_f32 v69, v69, v77
  v_add_f32 v85, v85, v93
  v_add_f32 v70, v70, v78
  v_add_f32 v86, v86, v94
  v_add_f32 v71, v71, v79
  v_add_f32 v87, v87, v95
  v_add_f32 v64, v64, v80
  v_add_f32 v65, v65, v81
  v_add_f32 v66, v66, v82
  v_add_f32 v67, v67, v83
  v_add_f32 v68, v68, v84
  v_add_f32 v69, v69, v85
  v_add_f32 v70, v70, v86
  v_add_f32 v71, v71, v87
  s_lshl_b32 s48, s49, 13
  s_add_u32 s48, s48, 528384
  v_add_u32 v7, s48, v7
  global_store_dwordx4 v7, v[64:67], s[26:27]
  global_store_dwordx4 v7, v[68:71], s[26:27] offset:16
  s_nop 1
A_fin:
A_end:
  s_endpgm
.p2align 8
.globl final_kernel
.type final_kernel,@function
final_kernel:
  s_cmp_ge_u32 s2, 64
  s_cbranch_scc1 B_end
  s_load_dwordx2 s[4:5], s[0:1], 0
  s_load_dwordx2 s[6:7], s[0:1], 72
  s_load_dwordx2 s[26:27], s[0:1], 88
  s_lshr_b32 s8, s2, 4
  s_and_b32 s9, s2, 15
  v_and_b32 v1, 7, v0
  v_lshrrev_b32 v2, 3, v0
  s_lshl_b32 s10, s9, 7
  v_lshl_add_u32 v3, v1, 4, s10
  s_lshl_b32 s11, s8, 17
  v_lshl_add_u32 v4, v2, 12, v3
  v_add_u32 v4, s11, v4
  s_lshl_b32 s11, s8, 9
  s_add_u32 s11, s11, 524288
  v_lshl_add_u32 v5, v2, 4, s11
  s_lshl_b32 s11, s8, 11
  v_lshl_add_u32 v6, v2, 13, v3
  v_add_u32 v6, s11, v6
  v_and_b32 v7, 31, v0
  s_lshl_b32 s11, s8, 10
  s_lshl_b32 s12, s9, 6
  s_add_u32 s11, s11, s12
  v_lshl_add_u32 v7, v7, 1, s11
  s_waitcnt lgkmcnt(0)
  s_add_u32 s16, s26, 528384
  s_addc_u32 s17, s27, 0
  s_mov_b32 s18, 352256
  s_mov_b32 s19, 0x20000
  global_load_dwordx4 v[8:11], v5, s[26:27]
  global_load_dwordx4 v[12:15], v4, s[26:27] offset:0
  global_load_dwordx4 v[16:19], v4, s[26:27] offset:2048
  buffer_load_dwordx4 v[20:23], v6, s[16:19], 0 offen
  v_add_u32 v6, 0x40000, v6
  buffer_load_dwordx4 v[24:27], v6, s[16:19], 0 offen
  global_load_ushort v28, v7, s[4:5]
  s_mov_b32 s13, 0x3fb8aa3b
  s_waitcnt vmcnt(5)
  v_max_f32 v30, v8, v10
  v_sub_f32 v8, v8, v30
  v_sub_f32 v10, v10, v30
  v_mul_f32 v8, s13, v8
  v_mul_f32 v10, s13, v10
  v_exp_f32 v8, v8
  v_exp_f32 v10, v10
  v_mul_f32 v30, v8, v9
  v_fmac_f32 v30, v10, v11
  v_rcp_f32 v31, v30
  s_nop 0
  v_fma_f32 v32, -v30, v31, 1.0
  v_fmac_f32 v31, v32, v31
  v_mul_f32 v8, v8, v31
  v_mul_f32 v10, v10, v31
  s_waitcnt vmcnt(3)
  v_mul_f32 v12, v8, v12
  v_fmac_f32 v12, v10, v16
  v_mul_f32 v13, v8, v13
  v_fmac_f32 v13, v10, v17
  v_mul_f32 v14, v8, v14
  v_fmac_f32 v14, v10, v18
  v_mul_f32 v15, v8, v15
  v_fmac_f32 v15, v10, v19
  s_waitcnt vmcnt(1)
  v_add_f32 v20, v20, v24
  v_add_f32 v21, v21, v25
  v_add_f32 v22, v22, v26
  v_add_f32 v23, v23, v27
  v_permlane32_swap_b32 v12, v20
  v_permlane32_swap_b32 v13, v21
  v_permlane32_swap_b32 v14, v22
  v_permlane32_swap_b32 v15, v23
  v_add_f32 v12, v12, v20
  v_add_f32 v13, v13, v21
  v_add_f32 v14, v14, v22
  v_add_f32 v15, v15, v23
  s_nop 0
  v_permlane16_swap_b32 v12, v14
  v_permlane16_swap_b32 v13, v15
  v_add_f32 v12, v12, v14
  v_add_f32 v13, v13, v15
  s_nop 0
  v_add_f32_dpp v12, v12, v12 row_ror:8 row_mask:0xf bank_mask:0xf
  v_add_f32_dpp v13, v13, v13 row_ror:8 row_mask:0xf bank_mask:0xf
  v_lshrrev_b32 v2, 6, v0
  v_lshlrev_b32 v2, 8, v2
  v_bfe_u32 v3, v0, 5, 1
  v_lshl_add_u32 v2, v3, 7, v2
  v_bfe_u32 v3, v0, 4, 1
  v_lshl_add_u32 v2, v3, 3, v2
  v_lshl_add_u32 v2, v1, 4, v2
  ds_write_b64 v2, v[12:13]
  s_waitcnt lgkmcnt(0)
  s_barrier
  v_cmp_gt_u32 vcc, 32, v0
  s_nop 1
  s_and_saveexec_b64 s[14:15], vcc
  s_cbranch_execz B_end
  v_lshlrev_b32 v2, 2, v0
  ds_read_b32 v8, v2 offset:0
  ds_read_b32 v12, v2 offset:128
  ds_read_b32 v9, v2 offset:256
  ds_read_b32 v13, v2 offset:384
  ds_read_b32 v10, v2 offset:512
  ds_read_b32 v14, v2 offset:640
  ds_read_b32 v11, v2 offset:768
  ds_read_b32 v15, v2 offset:896
  s_waitcnt lgkmcnt(0)
  v_add_f32 v8, v8, v9
  v_add_f32 v10, v10, v11
  v_add_f32 v8, v8, v10
  v_add_f32 v12, v12, v13
  v_add_f32 v14, v14, v15
  v_add_f32 v12, v12, v14
  v_cvt_pk_bf16_f32 v16, v8, v8
  v_and_b32 v8, 0xffff0000, v16
  v_cvt_pk_bf16_f32 v16, v12, v12
  v_and_b32 v12, 0xffff0000, v16
  v_mul_f32 v16, 0xbfb8aa3b, v12
  v_exp_f32 v16, v16
  s_nop 0
  v_add_f32 v16, 1.0, v16
  v_rcp_f32 v17, v16
  s_nop 0
  v_mul_f32 v12, v12, v17
  v_cvt_pk_bf16_f32 v16, v12, v12
  v_and_b32 v12, 0xffff0000, v16
  v_mul_f32 v8, v8, v12
  v_cvt_pk_bf16_f32 v16, v8, v8
  v_and_b32 v8, 0xffff0000, v16
  s_waitcnt vmcnt(0)
  v_lshlrev_b32 v28, 16, v28
  v_add_f32 v8, v8, v28
  v_cvt_pk_bf16_f32 v8, v8, v8
  global_store_short v7, v8, s[6:7]
B_end:
  s_endpgm
.section .rodata,"a"
.p2align 6
.amdhsa_kernel attn_ffn_kernel
  .amdhsa_next_free_vgpr 256
  .amdhsa_next_free_sgpr 100
  .amdhsa_accum_offset 256
  .amdhsa_group_segment_fixed_size 0
  .amdhsa_kernarg_size 96
  .amdhsa_user_sgpr_count 2
  .amdhsa_user_sgpr_kernarg_segment_ptr 1
  .amdhsa_system_sgpr_workgroup_id_x 1
  .amdhsa_float_denorm_mode_32 3
.end_amdhsa_kernel
.p2align 6
.amdhsa_kernel final_kernel
  .amdhsa_next_free_vgpr 40
  .amdhsa_next_free_sgpr 32
  .amdhsa_accum_offset 40
  .amdhsa_group_segment_fixed_size 0
  .amdhsa_kernarg_size 96
  .amdhsa_user_sgpr_count 2
  .amdhsa_user_sgpr_kernarg_segment_ptr 1
  .amdhsa_system_sgpr_workgroup_id_x 1
  .amdhsa_float_denorm_mode_32 3
.end_amdhsa_kernel
```
